```python
import torch

def _softmax(x, axis=-1):
    return torch.softmax(x, dim=axis)
def _gelu(x):
    return torch.nn.functional.gelu(x, approximate="tanh")
def _silu(x):
    return torch.nn.functional.silu(x)
def _sigmoid(x):
    return torch.sigmoid(x)
def _layernorm(x, axis=-1, eps=1e-5):
    m = x.mean(dim=axis, keepdim=True)
    v = x.var(dim=axis, keepdim=True, unbiased=False)
    return (x - m) / torch.sqrt(v + eps)
def _scatter_add(tgt, idx, src, axis=0):
    return tgt.clone().index_add_(axis, idx, src)
def _segment_sum(src, seg, n):
    out = torch.zeros((n,) + src.shape[1:], dtype=src.dtype)
    return out.index_add_(0, seg, src)
def _pad(x, pw):
    flat = tuple(v for pair in reversed(pw) for v in pair)
    return torch.nn.functional.pad(x, flat)

kernel_name = 'gated_mix__ssm_conv_s4__mixer_channel_mlp__prompt'

def setup_inputs():

    _w = (lambda a: (lambda t: t.to(torch.bfloat16) if t.is_floating_point() else t)(torch.as_tensor(a)))
    def _A_setup():
        B, L, D, N = 1, 2048, 512, 128
        A_re = -(lambda _x: torch.exp(torch.as_tensor(_x)))((lambda *s: torch.randn(*s, dtype=torch.bfloat16) * 3.2)(D, N))
        A_im = torch.pi * (lambda *s: torch.randn(*s, dtype=torch.bfloat16) * 0.1)(D, N)
        B_re = (lambda *s: torch.randn(*s, dtype=torch.bfloat16) * 0.2)(D, N)
        B_im = (lambda *s: torch.randn(*s, dtype=torch.bfloat16) * 0.2)(D, N)
        C_re = (lambda *s: torch.randn(*s, dtype=torch.bfloat16) * 0.2)(D, N)
        C_im = (lambda *s: torch.randn(*s, dtype=torch.bfloat16) * 0.2)(D, N)
        log_dt = (lambda *s: torch.randn(*s, dtype=torch.bfloat16) * 0.1)(D) * 0.5 - 4.0
        Dskip = (lambda *s: torch.randn(*s, dtype=torch.bfloat16) * 0.1)(D)
        return {
            "u": _w((lambda *s: torch.randn(*s, dtype=torch.bfloat16) * 0.05)(B, L, D)),
            "A_re": _w(A_re),
            "A_im": _w(A_im),
            "B_re": _w(B_re),
            "B_im": _w(B_im),
            "C_re": _w(C_re),
            "C_im": _w(C_im),
            "log_dt": _w(log_dt),
            "Dskip": _w(Dskip),
        }
    _A_in = _A_setup()

    def _B_setup():
        B, S, D, F = 1, 2048, 512, 1792
        return {
            "x": _w((lambda *s: torch.randn(*s, dtype=torch.bfloat16) * 0.05)(B, S, D)),
            "w1": _w((lambda *s: torch.randn(*s, dtype=torch.bfloat16) * 0.8)(D, F) * (D ** -0.5)),
            "b1": _w((lambda *s: torch.randn(*s, dtype=torch.bfloat16) * 0.2)(F)),
            "w2": _w((lambda *s: torch.randn(*s, dtype=torch.bfloat16) * 0.05)(F, D) * (F ** -0.5)),
            "b2": _w((lambda *s: torch.randn(*s, dtype=torch.bfloat16) * 0.05)(D)),
        }
    _B_in = _B_setup()

    return {
        "A_u": _A_in["u"],
        "A_A_re": _A_in["A_re"],
        "A_A_im": _A_in["A_im"],
        "A_B_re": _A_in["B_re"],
        "A_B_im": _A_in["B_im"],
        "A_C_re": _A_in["C_re"],
        "A_C_im": _A_in["C_im"],
        "A_log_dt": _A_in["log_dt"],
        "A_Dskip": _A_in["Dskip"],
        "B_x": _B_in["x"],
        "B_w1": _B_in["w1"],
        "B_b1": _B_in["b1"],
        "B_w2": _B_in["w2"],
        "B_b2": _B_in["b2"],
        "gate_w": _w((lambda *s: torch.randn(*s, dtype=torch.bfloat16) * 0.05)(512) * 16.0),
    }

def reference(A_u, A_A_re, A_A_im, A_B_re, A_B_im, A_C_re, A_C_im, A_log_dt, A_Dskip, B_x, B_w1, B_b1, B_w2, B_b2, gate_w):
    def _A_ref(u, A_re, A_im, B_re, B_im, C_re, C_im, log_dt, Dskip):
        Bsz, L, D = u.shape
        dt = torch.exp(log_dt)[:, None]
        A = A_re + 1j * A_im
        Bc = B_re + 1j * B_im
        Cc = C_re + 1j * C_im
        logdA = dt * A
        dB = dt * Bc
        l = (lambda x, dt: x.to(dt))(torch.arange(L), A_re.dtype)
        P = torch.exp(logdA[:, :, None] * l[None, None, :])
        K = torch.einsum("dn,dnl,dn->dl", Cc, P, dB).real
        L2 = 2 * L
        Kp = _pad(K, ((0, 0), (0, L)))
        up = (lambda x, *d: x.permute(*d))(u, 0, 2, 1)
        up = _pad(up, ((0, 0), (0, 0), (0, L)))
        Kf = (lambda x, axes=(-2,-1): torch.fft.rfft2(x.float(), dim=axes))(Kp[:, None, :], axes=(-2, -1))
        Uf = (lambda x, axes=(-2,-1): torch.fft.rfft2(x.float(), dim=axes))(up[:, :, None, :], axes=(-2, -1))
        Yf = Uf * Kf[None, :, :, :]
        y = (lambda x, s, axes=(-2,-1): torch.fft.irfft2(x, s=s, dim=axes).to(torch.bfloat16))(Yf, (1, L2), axes=(-2, -1))[:, :, 0, :L]
        y = (lambda x, *d: x.permute(*d))(y, 0, 2, 1) + u * Dskip[None, None, :]
        return y

    def _B_ref(x, w1, b1, w2, b2):
        y = _layernorm(x, axis=-1)
        h = _gelu(torch.einsum("bsd,df->bsf", y, w1) + b1)
        return torch.einsum("bsf,fd->bsd", h, w2) + b2

    x = A_u
    g = _sigmoid((x * gate_w).sum(-1, keepdims=True))
    a = _A_ref(x, A_A_re, A_A_im, A_B_re, A_B_im, A_C_re, A_C_im, A_log_dt, A_Dskip)
    b = _B_ref(x, B_w1, B_b1, B_w2, B_b2)
    return g * a + (1 - g) * b
```

```asm
; @launch grid=(512,1,1) block=(256,1,1) lds=81920
.amdgcn_target "amdgcn-amd-amdhsa--gfx950"
.text
.globl gated_mix__ssm_conv_s4__mixer_channel_mlp__prompt_kernel
.p2align 8
.type gated_mix__ssm_conv_s4__mixer_channel_mlp__prompt_kernel,@function
gated_mix__ssm_conv_s4__mixer_channel_mlp__prompt_kernel:
CODE_BEGIN:
    s_cmp_ge_u32 s2, 512
    s_cbranch_scc1 L_exit
    s_load_dwordx16 s[4:19], s[0:1], 0
    s_load_dwordx16 s[20:35], s[0:1], 64
    s_load_dwordx4 s[36:39], s[0:1], 128
    v_lshrrev_b32 v2, 6, v0
    v_and_b32 v1, 63, v0
    v_readfirstlane_b32 s40, v2
    s_cmp_lt_u32 s2, 256
    s_cbranch_scc1 L_ssm
    s_cmp_eq_u32 s2, 488
    s_cbranch_scc0 L_gemm
    s_setprio 3
    v_lshlrev_b32 v2, 4, v0
    v_mov_b32 v4, 0
    v_mov_b32 v5, 0
    v_mov_b32 v6, 0
    v_mov_b32 v7, 0
    s_waitcnt lgkmcnt(0)
    s_add_u32 s64, s38, 0xb10000
    s_addc_u32 s65, s39, 0
    s_mov_b32 s66, 0x8000
    s_mov_b32 s67, 0x20000
    buffer_store_dwordx4 v[4:7], v2, s[64:67], 0 offen sc1
    s_nop 1
    v_add_u32 v2, 4096, v2
    buffer_store_dwordx4 v[4:7], v2, s[64:67], 0 offen sc1
    s_nop 1
    v_add_u32 v2, 4096, v2
    buffer_store_dwordx4 v[4:7], v2, s[64:67], 0 offen sc1
    s_nop 1
    v_add_u32 v2, 4096, v2
    buffer_store_dwordx4 v[4:7], v2, s[64:67], 0 offen sc1
    s_nop 1
    v_add_u32 v2, 4096, v2
    buffer_store_dwordx4 v[4:7], v2, s[64:67], 0 offen sc1
    s_nop 1
    v_add_u32 v2, 4096, v2
    buffer_store_dwordx4 v[4:7], v2, s[64:67], 0 offen sc1
    s_nop 1
    v_add_u32 v2, 4096, v2
    buffer_store_dwordx4 v[4:7], v2, s[64:67], 0 offen sc1
    s_nop 1
    v_add_u32 v2, 4096, v2
    buffer_store_dwordx4 v[4:7], v2, s[64:67], 0 offen sc1
    s_mov_b32 s68, s36
    s_mov_b32 s69, s37
    s_mov_b32 s70, 0x100
    s_mov_b32 s71, 0x20000
    v_mov_b32 v2, 0
    v_mov_b32 v3, 1
    s_waitcnt vmcnt(0)
    s_barrier
    s_cmp_eq_u32 s40, 0
    s_cbranch_scc0 L_gemm
    s_mov_b64 exec, 1
    buffer_store_dword v3, v2, s[68:71], 0 offen sc1
    s_mov_b64 exec, -1
L_gemm:
    s_sub_u32 s41, s2, 256
    s_setprio 2
    s_and_b32 s75, s41, 7
    s_lshr_b32 s74, s41, 3
    s_cmp_ge_u32 s74, 28
    s_cbranch_scc1 L_service
    s_mul_i32 s42, s74, 37
    s_lshr_b32 s42, s42, 8
    s_mul_i32 s43, s42, 7
    s_sub_u32 s43, s74, s43
    s_lshr_b32 s44, s75, 1
    s_lshl_b32 s44, s44, 2
    s_add_u32 s72, s44, s42
    s_and_b32 s44, s75, 1
    s_mul_i32 s44, s44, 7
    s_add_u32 s73, s44, s43
    s_lshl_b32 s42, s42, 1
    s_add_u32 s42, s42, s43
    s_and_b32 s79, s42, 7
    s_and_b32 s82, s40, 1
    s_lshr_b32 s83, s40, 1
    v_lshrrev_b32 v12, 3, v1
    v_and_b32 v13, 7, v1
    v_lshrrev_b32 v14, 1, v12
    v_xor_b32 v14, v13, v14
    s_lshl_b32 s42, s40, 4
    v_add_u32 v15, s42, v12
    v_lshlrev_b32 v15, 10, v15
    v_lshl_add_u32 v2, v14, 4, v15
    v_xor_b32 v14, 4, v14
    v_lshl_add_u32 v3, v14, 4, v15
    v_add_u32 v3, 7168, v3
    v_lshrrev_b32 v12, 4, v1
    v_and_b32 v13, 15, v1
    v_lshrrev_b32 v14, 2, v13
    v_xor_b32 v14, v14, v12
    v_and_b32 v13, 3, v13
    v_lshl_add_u32 v14, v14, 2, v13
    s_lshl_b32 s42, s40, 3
    v_add_u32 v15, s42, v12
    v_mul_u32_u24 v15, 3584, v15
    v_lshl_add_u32 v6, v14, 4, v15
    v_add_u32 v7, 13312, v6
    s_lshl_b32 s84, s40, 11
    s_waitcnt lgkmcnt(0)
    s_add_u32 s42, s79, 0
    s_and_b32 s42, s42, 7
    s_lshl_b32 s6, s42, 7
    s_mul_i32 s14, s42, 229376
    s_add_u32 s42, s79, 1
    s_and_b32 s42, s42, 7
    s_lshl_b32 s7, s42, 7
    s_mul_i32 s15, s42, 229376
    s_lshl_b32 s42, s72, 17
    s_add_u32 s52, s4, s42
    s_addc_u32 s53, s5, 0
    s_mov_b32 s54, 0x20000
    s_mov_b32 s55, 0x20000
    s_lshl_b32 s42, s73, 8
    s_sub_u32 s43, 1835008, s42
    s_add_u32 s56, s24, s42
    s_addc_u32 s57, s25, 0
    s_mov_b32 s58, s43
    s_mov_b32 s59, 0x20000
    s_add_u32 m0, s84, 49152
    s_nop 0
    buffer_load_dwordx4 v6, s[56:59], s14 offen lds
    buffer_load_dwordx4 v7, s[56:59], s14 offen offset:1024 lds
    s_add_u32 m0, s84, 0
    s_nop 0
    buffer_load_dwordx4 v2, s[52:55], s6 offen lds
    buffer_load_dwordx4 v3, s[52:55], s6 offen offset:1024 lds
    v_add_u32 v4, 65536, v2
    v_add_u32 v5, 65536, v3
    v_add_u32 v8, 114688, v6
    v_add_u32 v9, 114688, v7
    s_add_u32 m0, s84, 8192
    s_nop 0
    buffer_load_dwordx4 v4, s[52:55], s6 offen lds
    buffer_load_dwordx4 v5, s[52:55], s6 offen offset:1024 lds
    s_add_u32 m0, s84, 57344
    s_nop 0
    buffer_load_dwordx4 v8, s[56:59], s14 offen lds
    buffer_load_dwordx4 v9, s[56:59], s14 offen offset:1024 lds
    s_add_u32 m0, s84, 16384
    s_nop 0
    buffer_load_dwordx4 v2, s[52:55], s7 offen lds
    buffer_load_dwordx4 v3, s[52:55], s7 offen offset:1024 lds
    s_add_u32 m0, s84, 24576
    s_nop 0
    buffer_load_dwordx4 v4, s[52:55], s7 offen lds
    buffer_load_dwordx4 v5, s[52:55], s7 offen offset:1024 lds
    s_add_u32 m0, s84, 65536
    s_nop 0
    buffer_load_dwordx4 v6, s[56:59], s15 offen lds
    buffer_load_dwordx4 v7, s[56:59], s15 offen offset:1024 lds
    s_add_u32 s42, s79, 2
    s_and_b32 s42, s42, 7
    s_lshl_b32 s8, s42, 7
    s_mul_i32 s16, s42, 229376
    s_add_u32 s42, s79, 3
    s_and_b32 s42, s42, 7
    s_lshl_b32 s9, s42, 7
    s_mul_i32 s17, s42, 229376
    s_add_u32 s42, s79, 4
    s_and_b32 s42, s42, 7
    s_lshl_b32 s10, s42, 7
    s_mul_i32 s18, s42, 229376
    s_add_u32 s42, s79, 5
    s_and_b32 s42, s42, 7
    s_lshl_b32 s11, s42, 7
    s_mul_i32 s19, s42, 229376
    s_add_u32 s42, s79, 6
    s_and_b32 s42, s42, 7
    s_lshl_b32 s12, s42, 7
    s_mul_i32 s20, s42, 229376
    s_add_u32 s42, s79, 7
    s_and_b32 s42, s42, 7
    s_lshl_b32 s13, s42, 7
    s_mul_i32 s21, s42, 229376
    s_lshl_b32 s42, s73, 7
    s_lshl_b32 s43, s82, 6
    s_add_u32 s42, s42, s43
    v_and_b32 v21, 31, v1
    v_add_u32 v22, s42, v21
    v_lshlrev_b32 v22, 1, v22
    s_lshl_b32 s42, s83, 6
    v_add_u32 v23, s42, v22
    global_load_ushort v26, v23, s[26:27]
    s_sub_u32 s42, 64, s42
    v_add_u32 v23, s42, v22
    global_load_ushort v27, v23, s[26:27]
    s_add_u32 s64, s38, 0xb10000
    s_addc_u32 s65, s39, 0
    s_mov_b32 s66, 0x8000
    s_mov_b32 s67, 0x20000
    s_mov_b32 s68, s36
    s_mov_b32 s69, s37
    s_mov_b32 s70, 0x100
    s_mov_b32 s71, 0x20000
    s_mov_b32 s48, s38
    s_mov_b32 s49, s39
    s_mov_b32 s50, 0x1000000
    s_mov_b32 s51, 0x20000
    s_lshr_b32 s42, s75, 1
    s_lshl_b32 s42, s42, 3
    s_lshr_b32 s44, s74, 2
    s_add_u32 s87, s42, s44
    s_and_b32 s42, s75, 1
    s_lshl_b32 s42, s42, 2
    s_and_b32 s43, s74, 3
    s_add_u32 s88, s42, s43
    s_and_b32 s76, s87, 1
    s_lshl_b32 s42, s43, 1
    s_add_u32 s42, s42, s44
    s_cmp_ge_u32 s42, 7
    s_cselect_b32 s43, 7, 0
    s_sub_u32 s42, s42, s43
    s_mul_i32 s44, s40, 28672
    s_lshl_b32 s43, s42, 12
    s_add_u32 s90, s43, s44
    s_add_u32 s42, s42, 1
    s_cmp_eq_u32 s42, 7
    s_cselect_b32 s42, 0, s42
    s_lshl_b32 s43, s42, 12
    s_add_u32 s91, s43, s44
    s_add_u32 s42, s42, 1
    s_cmp_eq_u32 s42, 7
    s_cselect_b32 s42, 0, s42
    s_lshl_b32 s43, s42, 12
    s_add_u32 s92, s43, s44
    s_add_u32 s42, s42, 1
    s_cmp_eq_u32 s42, 7
    s_cselect_b32 s42, 0, s42
    s_lshl_b32 s43, s42, 12
    s_add_u32 s93, s43, s44
    s_add_u32 s42, s42, 1
    s_cmp_eq_u32 s42, 7
    s_cselect_b32 s42, 0, s42
    s_lshl_b32 s43, s42, 12
    s_add_u32 s94, s43, s44
    s_add_u32 s42, s42, 1
    s_cmp_eq_u32 s42, 7
    s_cselect_b32 s42, 0, s42
    s_lshl_b32 s43, s42, 12
    s_add_u32 s95, s43, s44
    s_add_u32 s42, s42, 1
    s_cmp_eq_u32 s42, 7
    s_cselect_b32 s42, 0, s42
    s_lshl_b32 s43, s42, 12
    s_add_u32 s96, s43, s44
    s_lshl_b32 s97, s76, 15
    s_add_u32 s98, s97, 16384
    s_sub_u32 s99, 32768, s97
    s_add_u32 s100, s99, 16384
    s_lshl_b32 s42, s88, 7
    s_sub_u32 s43, 1835008, s42
    s_add_u32 s24, s28, s42
    s_addc_u32 s25, s29, 0
    s_mov_b32 s26, s43
    s_mov_b32 s27, 0x20000
    s_mul_i32 s42, s87, 229376
    s_add_u32 s42, s42, 0x400000
    s_add_u32 s60, s38, s42
    s_addc_u32 s61, s39, 0
    s_mov_b32 s62, 0x38000
    s_mov_b32 s63, 0x20000
    s_and_b32 s82, s40, 1
    s_lshr_b32 s83, s40, 1
    v_lshrrev_b32 v96, 3, v1
    v_and_b32 v97, 7, v1
    v_lshrrev_b32 v98, 2, v97
    v_lshrrev_b32 v99, 1, v96
    v_and_b32 v99, 1, v99
    v_xor_b32 v98, v98, v99
    v_and_b32 v97, 3, v97
    v_lshl_add_u32 v98, v98, 2, v97
    v_lshlrev_b32 v96, 10, v96
    v_lshl_add_u32 v128, v98, 4, v96
    v_add_u32 v129, 7168, v128
    s_lshl_b32 s81, s40, 12
    s_lshl_b32 s80, s40, 11
    v_lshrrev_b32 v96, 4, v1
    v_and_b32 v97, 15, v1
    v_lshrrev_b32 v98, 2, v97
    v_and_b32 v97, 3, v97
    v_lshrrev_b32 v99, 1, v96
    v_and_b32 v96, 1, v96
    v_lshl_add_u32 v99, v99, 2, v98
    v_lshlrev_b32 v99, 7, v99
    v_lshl_add_u32 v99, v96, 5, v99
    v_lshl_add_u32 v99, v97, 3, v99
    v_lshrrev_b32 v98, 1, v98
    v_xor_b32 v98, s82, v98
    v_lshl_add_u32 v130, v98, 6, v99
    v_xor_b32 v98, 1, v98
    v_lshl_add_u32 v131, v98, 6, v99
    s_add_u32 s42, s80, 49152
    v_add_u32 v218, s42, v130
    v_add_u32 v130, s81, v130
    v_add_u32 v219, s42, v131
    v_add_u32 v131, s81, v131
    v_lshlrev_b32 v98, 4, v1
    s_lshl_b32 s43, s76, 11
    v_add_u32 v98, s43, v98
    s_mul_i32 s42, s83, 114688
    v_add_u32 v132, s42, v98
    s_sub_u32 s42, 114688, s42
    v_add_u32 v133, s42, v98
    s_lshl_b32 s43, s43, 1
    s_sub_u32 s43, 2048, s43
    v_add_u32 v134, s43, v132
    v_add_u32 v135, s43, v133
    s_lshr_b32 s42, s87, 1
    s_mul_i32 s42, s42, 14
    s_mul_i32 s43, s40, 7
    s_lshr_b32 s43, s43, 1
    s_add_u32 s42, s42, s43
    s_lshl_b32 s42, s42, 6
    s_lshl_b32 s43, s76, 3
    s_add_u32 s42, s42, s43
    s_add_u32 s42, s42, 0xb14000
    s_add_u32 s32, s38, s42
    s_addc_u32 s33, s39, 0
    s_lshl_b32 s42, s88, 5
    v_add_u32 v137, s42, v1
    v_lshlrev_b32 v137, 5, v137
    v_add_u32 v137, 8192, v137
    s_lshr_b32 s42, s87, 2
    s_and_b32 s43, s87, 3
    s_lshl_b32 s43, s43, 6
    s_add_u32 s42, s42, s43
    v_subrev_u32 v96, 32, v1
    v_lshlrev_b32 v96, 3, v96
    v_add_u32 v96, s42, v96
    v_lshlrev_b32 v96, 5, v96
    v_add_u32 v96, 0, v96
    v_cmp_gt_u32 vcc, 32, v1
    s_nop 1
    v_cndmask_b32 v137, v96, v137, vcc
    v_lshrrev_b32 v12, 4, v1
    v_and_b32 v13, 15, v1
    v_lshrrev_b32 v14, 2, v13
    v_and_b32 v13, 3, v13
    v_lshrrev_b32 v15, 1, v12
    v_and_b32 v12, 1, v12
    v_lshl_add_u32 v15, v15, 3, v14
    v_lshlrev_b32 v15, 8, v15
    v_lshl_add_u32 v15, v12, 5, v15
    v_lshl_add_u32 v15, v13, 3, v15
    v_add_u32 v15, 49152, v15
    s_lshl_b32 s42, s82, 1
    s_add_u32 s42, s42, s83
    v_xor_b32 v12, s42, v14
    v_lshl_add_u32 v10, v12, 6, v15
    s_xor_b32 s42, s42, 1
    v_xor_b32 v12, s42, v14
    v_lshl_add_u32 v11, v12, 6, v15
    v_and_b32 v12, 31, v1
    v_lshrrev_b32 v13, 5, v1
    v_lshrrev_b32 v14, 1, v12
    v_and_b32 v14, 7, v14
    s_lshl_b32 s42, s83, 6
    v_add_u32 v12, s42, v12
    v_lshlrev_b32 v12, 7, v12
    v_add_u32 v15, 0, v13
    v_xor_b32 v15, v15, v14
    v_lshl_add_u32 v16, v15, 4, v12
    v_add_u32 v15, 2, v13
    v_xor_b32 v15, v15, v14
    v_lshl_add_u32 v17, v15, 4, v12
    v_add_u32 v15, 4, v13
    v_xor_b32 v15, v15, v14
    v_lshl_add_u32 v18, v15, 4, v12
    v_add_u32 v15, 6, v13
    v_xor_b32 v15, v15, v14
    v_lshl_add_u32 v19, v15, 4, v12
    v_mov_b32 v248, 0x3f803f80
    v_mov_b32 v249, 0x3f803f80
    v_mov_b32 v250, 0x3f803f80
    v_mov_b32 v251, 0x3f803f80
    v_mov_b32 v28, 0
    s_lshr_b32 s42, s72, 1
    s_and_b32 s43, s72, 1
    s_lshl_b32 s43, s43, 7
    s_add_u32 s42, s42, s43
    v_lshlrev_b32 v29, 3, v1
    v_add_u32 v29, s42, v29
    v_lshlrev_b32 v29, 5, v29
    s_lshl_b32 s42, s72, 7
    s_lshl_b32 s43, s83, 6
    s_add_u32 s42, s42, s43
    v_add_u32 v30, s42, v21
    v_lshlrev_b32 v30, 3, v30
    v_add_u32 v30, 0xb02000, v30
    s_lshl_b32 s77, s83, 11
    s_sub_u32 s78, 2048, s77
    s_lshl_b32 s42, s72, 2
    s_lshl_b32 s43, s83, 1
    s_add_u32 s42, s42, s43
    s_mul_i32 s42, s42, 112
    s_lshl_b32 s43, s73, 3
    s_add_u32 s42, s42, s43
    s_lshl_b32 s43, s82, 2
    s_add_u32 s42, s42, s43
    s_lshl_b32 s42, s42, 10
    s_add_u32 s42, s42, 0x400000
    v_lshlrev_b32 v24, 4, v1
    v_add_u32 v24, s42, v24
    v_add_u32 v25, 114688, v24
    s_add_u32 s44, s80, 65536
    s_xor_b32 s45, s40, 2
    s_lshl_b32 s45, s45, 11
    s_add_u32 s45, s45, 65536
    v_lshlrev_b32 v21, 2, v21
    v_add_u32 v23, s45, v21
    v_add_u32 v21, s44, v21
    s_waitcnt vmcnt(8)
    s_barrier
    ds_read_b64_tr_b16 v[96:97], v10 offset:0
    ds_read_b64_tr_b16 v[98:99], v10 offset:1024
    ds_read_b64_tr_b16 v[100:101], v11 offset:0
    ds_read_b64_tr_b16 v[102:103], v11 offset:1024
    ds_read_b128 v[104:107], v16 offset:0
    ds_read_b128 v[108:111], v16 offset:4096
    s_waitcnt lgkmcnt(4)
    v_mfma_f32_32x32x16_bf16 v[232:247], v[248:251], v[96:99], 0
    ds_read_b64_tr_b16 v[112:113], v10 offset:4096
    ds_read_b64_tr_b16 v[114:115], v10 offset:5120
    s_waitcnt lgkmcnt(3)
    v_mfma_f32_32x32x16_bf16 v[32:47], v[96:99], v[104:107], 0
    s_add_u32 m0, s84, 73728
    s_nop 0
    buffer_load_dwordx4 v8, s[56:59], s15 offen lds
    ds_read_b64_tr_b16 v[116:117], v11 offset:4096
    s_waitcnt lgkmcnt(3)
    v_mfma_f32_32x32x16_bf16 v[48:63], v[96:99], v[108:111], 0
    ds_read_b64_tr_b16 v[118:119], v11 offset:5120
    ds_read_b128 v[120:123], v17 offset:0
    v_mfma_f32_32x32x16_bf16 v[64:79], v[100:103], v[104:107], 0
    buffer_load_dwordx4 v9, s[56:59], s15 offen offset:1024 lds
    ds_read_b128 v[124:127], v17 offset:4096
    v_mfma_f32_32x32x16_bf16 v[80:95], v[100:103], v[108:111], 0
    s_waitcnt lgkmcnt(4)
    v_mfma_f32_32x32x16_bf16 v[232:247], v[248:251], v[112:115], v[232:247]
    ds_read_b64_tr_b16 v[96:97], v10 offset:8192
    ds_read_b64_tr_b16 v[98:99], v10 offset:9216
    s_waitcnt lgkmcnt(3)
    v_mfma_f32_32x32x16_bf16 v[32:47], v[112:115], v[120:123], v[32:47]
    s_add_u32 m0, s84, 32768
    s_nop 0
    buffer_load_dwordx4 v2, s[52:55], s8 offen lds
    ds_read_b64_tr_b16 v[100:101], v11 offset:8192
    s_waitcnt lgkmcnt(3)
    v_mfma_f32_32x32x16_bf16 v[48:63], v[112:115], v[124:127], v[48:63]
    ds_read_b64_tr_b16 v[102:103], v11 offset:9216
    ds_read_b128 v[104:107], v18 offset:0
    v_mfma_f32_32x32x16_bf16 v[64:79], v[116:119], v[120:123], v[64:79]
    buffer_load_dwordx4 v3, s[52:55], s8 offen offset:1024 lds
    ds_read_b128 v[108:111], v18 offset:4096
    v_mfma_f32_32x32x16_bf16 v[80:95], v[116:119], v[124:127], v[80:95]
    s_waitcnt vmcnt(6)
    s_barrier
    s_waitcnt lgkmcnt(4)
    v_mfma_f32_32x32x16_bf16 v[232:247], v[248:251], v[96:99], v[232:247]
    ds_read_b64_tr_b16 v[112:113], v10 offset:12288
    ds_read_b64_tr_b16 v[114:115], v10 offset:13312
    s_waitcnt lgkmcnt(3)
    v_mfma_f32_32x32x16_bf16 v[32:47], v[96:99], v[104:107], v[32:47]
    s_add_u32 m0, s84, 49152
    s_nop 0
    buffer_load_dwordx4 v6, s[56:59], s16 offen lds
    ds_read_b64_tr_b16 v[116:117], v11 offset:12288
    s_waitcnt lgkmcnt(3)
    v_mfma_f32_32x32x16_bf16 v[48:63], v[96:99], v[108:111], v[48:63]
    ds_read_b64_tr_b16 v[118:119], v11 offset:13312
    ds_read_b128 v[120:123], v19 offset:0
    v_mfma_f32_32x32x16_bf16 v[64:79], v[100:103], v[104:107], v[64:79]
    buffer_load_dwordx4 v7, s[56:59], s16 offen offset:1024 lds
    ds_read_b128 v[124:127], v19 offset:4096
    v_mfma_f32_32x32x16_bf16 v[80:95], v[100:103], v[108:111], v[80:95]
    s_waitcnt lgkmcnt(4)
    v_mfma_f32_32x32x16_bf16 v[232:247], v[248:251], v[112:115], v[232:247]
    ds_read_b64_tr_b16 v[96:97], v10 offset:16384
    ds_read_b64_tr_b16 v[98:99], v10 offset:17408
    s_waitcnt lgkmcnt(3)
    v_mfma_f32_32x32x16_bf16 v[32:47], v[112:115], v[120:123], v[32:47]
    s_add_u32 m0, s84, 40960
    s_nop 0
    buffer_load_dwordx4 v4, s[52:55], s8 offen lds
    ds_read_b64_tr_b16 v[100:101], v11 offset:16384
    s_waitcnt lgkmcnt(3)
    v_mfma_f32_32x32x16_bf16 v[48:63], v[112:115], v[124:127], v[48:63]
    ds_read_b64_tr_b16 v[102:103], v11 offset:17408
    ds_read_b128 v[104:107], v16 offset:16384
    v_mfma_f32_32x32x16_bf16 v[64:79], v[116:119], v[120:123], v[64:79]
    buffer_load_dwordx4 v5, s[52:55], s8 offen offset:1024 lds
    ds_read_b128 v[108:111], v16 offset:20480
    v_mfma_f32_32x32x16_bf16 v[80:95], v[116:119], v[124:127], v[80:95]
    s_waitcnt vmcnt(6)
    s_barrier
    s_waitcnt lgkmcnt(4)
    v_mfma_f32_32x32x16_bf16 v[232:247], v[248:251], v[96:99], v[232:247]
    ds_read_b64_tr_b16 v[112:113], v10 offset:20480
    ds_read_b64_tr_b16 v[114:115], v10 offset:21504
    s_waitcnt lgkmcnt(3)
    v_mfma_f32_32x32x16_bf16 v[32:47], v[96:99], v[104:107], v[32:47]
    s_add_u32 m0, s84, 57344
    s_nop 0
    buffer_load_dwordx4 v8, s[56:59], s16 offen lds
    ds_read_b64_tr_b16 v[116:117], v11 offset:20480
    s_waitcnt lgkmcnt(3)
    v_mfma_f32_32x32x16_bf16 v[48:63], v[96:99], v[108:111], v[48:63]
    ds_read_b64_tr_b16 v[118:119], v11 offset:21504
    ds_read_b128 v[120:123], v17 offset:16384
    v_mfma_f32_32x32x16_bf16 v[64:79], v[100:103], v[104:107], v[64:79]
    buffer_load_dwordx4 v9, s[56:59], s16 offen offset:1024 lds
    ds_read_b128 v[124:127], v17 offset:20480
    v_mfma_f32_32x32x16_bf16 v[80:95], v[100:103], v[108:111], v[80:95]
    s_waitcnt lgkmcnt(4)
    v_mfma_f32_32x32x16_bf16 v[232:247], v[248:251], v[112:115], v[232:247]
    ds_read_b64_tr_b16 v[96:97], v10 offset:24576
    ds_read_b64_tr_b16 v[98:99], v10 offset:25600
    s_waitcnt lgkmcnt(3)
    v_mfma_f32_32x32x16_bf16 v[32:47], v[112:115], v[120:123], v[32:47]
    s_add_u32 m0, s84, 0
    s_nop 0
    buffer_load_dwordx4 v2, s[52:55], s9 offen lds
    ds_read_b64_tr_b16 v[100:101], v11 offset:24576
    s_waitcnt lgkmcnt(3)
    v_mfma_f32_32x32x16_bf16 v[48:63], v[112:115], v[124:127], v[48:63]
    ds_read_b64_tr_b16 v[102:103], v11 offset:25600
    ds_read_b128 v[104:107], v18 offset:16384
    v_mfma_f32_32x32x16_bf16 v[64:79], v[116:119], v[120:123], v[64:79]
    buffer_load_dwordx4 v3, s[52:55], s9 offen offset:1024 lds
    ds_read_b128 v[108:111], v18 offset:20480
    v_mfma_f32_32x32x16_bf16 v[80:95], v[116:119], v[124:127], v[80:95]
    s_waitcnt vmcnt(4)
    s_barrier
    s_waitcnt lgkmcnt(4)
    v_mfma_f32_32x32x16_bf16 v[232:247], v[248:251], v[96:99], v[232:247]
    ds_read_b64_tr_b16 v[112:113], v10 offset:28672
    ds_read_b64_tr_b16 v[114:115], v10 offset:29696
    s_waitcnt lgkmcnt(3)
    v_mfma_f32_32x32x16_bf16 v[32:47], v[96:99], v[104:107], v[32:47]
    s_add_u32 m0, s84, 65536
    s_nop 0
    buffer_load_dwordx4 v6, s[56:59], s17 offen lds
    ds_read_b64_tr_b16 v[116:117], v11 offset:28672
    s_waitcnt lgkmcnt(3)
    v_mfma_f32_32x32x16_bf16 v[48:63], v[96:99], v[108:111], v[48:63]
    ds_read_b64_tr_b16 v[118:119], v11 offset:29696
    ds_read_b128 v[120:123], v19 offset:16384
    v_mfma_f32_32x32x16_bf16 v[64:79], v[100:103], v[104:107], v[64:79]
    buffer_load_dwordx4 v7, s[56:59], s17 offen offset:1024 lds
    ds_read_b128 v[124:127], v19 offset:20480
    v_mfma_f32_32x32x16_bf16 v[80:95], v[100:103], v[108:111], v[80:95]
    s_waitcnt lgkmcnt(4)
    v_mfma_f32_32x32x16_bf16 v[232:247], v[248:251], v[112:115], v[232:247]
    ds_read_b64_tr_b16 v[96:97], v10 offset:0
    ds_read_b64_tr_b16 v[98:99], v10 offset:1024
    s_waitcnt lgkmcnt(3)
    v_mfma_f32_32x32x16_bf16 v[32:47], v[112:115], v[120:123], v[32:47]
    s_add_u32 m0, s84, 8192
    s_nop 0
    buffer_load_dwordx4 v4, s[52:55], s9 offen lds
    ds_read_b64_tr_b16 v[100:101], v11 offset:0
    s_waitcnt lgkmcnt(3)
    v_mfma_f32_32x32x16_bf16 v[48:63], v[112:115], v[124:127], v[48:63]
    ds_read_b64_tr_b16 v[102:103], v11 offset:1024
    ds_read_b128 v[104:107], v16 offset:32768
    v_mfma_f32_32x32x16_bf16 v[64:79], v[116:119], v[120:123], v[64:79]
    buffer_load_dwordx4 v5, s[52:55], s9 offen offset:1024 lds
    ds_read_b128 v[108:111], v16 offset:36864
    v_mfma_f32_32x32x16_bf16 v[80:95], v[116:119], v[124:127], v[80:95]
    s_waitcnt vmcnt(6)
    s_barrier
    s_mov_b64 exec, 0x1
    buffer_load_dword v31, v28, s[68:71], 0 offen offset:0 sc1
    s_mov_b64 exec, -1
    s_waitcnt lgkmcnt(4)
    v_mfma_f32_32x32x16_bf16 v[232:247], v[248:251], v[96:99], v[232:247]
    ds_read_b64_tr_b16 v[112:113], v10 offset:4096
    ds_read_b64_tr_b16 v[114:115], v10 offset:5120
    s_waitcnt lgkmcnt(3)
    v_mfma_f32_32x32x16_bf16 v[32:47], v[96:99], v[104:107], v[32:47]
    s_add_u32 m0, s84, 73728
    s_nop 0
    buffer_load_dwordx4 v8, s[56:59], s17 offen lds
    ds_read_b64_tr_b16 v[116:117], v11 offset:4096
    s_waitcnt lgkmcnt(3)
    v_mfma_f32_32x32x16_bf16 v[48:63], v[96:99], v[108:111], v[48:63]
    ds_read_b64_tr_b16 v[118:119], v11 offset:5120
    ds_read_b128 v[120:123], v17 offset:32768
    v_mfma_f32_32x32x16_bf16 v[64:79], v[100:103], v[104:107], v[64:79]
    buffer_load_dwordx4 v9, s[56:59], s17 offen offset:1024 lds
    ds_read_b128 v[124:127], v17 offset:36864
    v_mfma_f32_32x32x16_bf16 v[80:95], v[100:103], v[108:111], v[80:95]
    s_waitcnt lgkmcnt(4)
    v_mfma_f32_32x32x16_bf16 v[232:247], v[248:251], v[112:115], v[232:247]
    ds_read_b64_tr_b16 v[96:97], v10 offset:8192
    ds_read_b64_tr_b16 v[98:99], v10 offset:9216
    s_waitcnt lgkmcnt(3)
    v_mfma_f32_32x32x16_bf16 v[32:47], v[112:115], v[120:123], v[32:47]
    s_add_u32 m0, s84, 16384
    s_nop 0
    buffer_load_dwordx4 v2, s[52:55], s10 offen lds
    ds_read_b64_tr_b16 v[100:101], v11 offset:8192
    s_waitcnt lgkmcnt(3)
    v_mfma_f32_32x32x16_bf16 v[48:63], v[112:115], v[124:127], v[48:63]
    ds_read_b64_tr_b16 v[102:103], v11 offset:9216
    ds_read_b128 v[104:107], v18 offset:32768
    v_mfma_f32_32x32x16_bf16 v[64:79], v[116:119], v[120:123], v[64:79]
    buffer_load_dwordx4 v3, s[52:55], s10 offen offset:1024 lds
    ds_read_b128 v[108:111], v18 offset:36864
    v_mfma_f32_32x32x16_bf16 v[80:95], v[116:119], v[124:127], v[80:95]
    s_waitcnt vmcnt(5)
    s_barrier
    s_waitcnt lgkmcnt(4)
    v_mfma_f32_32x32x16_bf16 v[232:247], v[248:251], v[96:99], v[232:247]
    ds_read_b64_tr_b16 v[112:113], v10 offset:12288
    ds_read_b64_tr_b16 v[114:115], v10 offset:13312
    s_waitcnt lgkmcnt(3)
    v_mfma_f32_32x32x16_bf16 v[32:47], v[96:99], v[104:107], v[32:47]
    s_add_u32 m0, s84, 49152
    s_nop 0
    buffer_load_dwordx4 v6, s[56:59], s18 offen lds
    ds_read_b64_tr_b16 v[116:117], v11 offset:12288
    s_waitcnt lgkmcnt(3)
    v_mfma_f32_32x32x16_bf16 v[48:63], v[96:99], v[108:111], v[48:63]
    ds_read_b64_tr_b16 v[118:119], v11 offset:13312
    ds_read_b128 v[120:123], v19 offset:32768
    v_mfma_f32_32x32x16_bf16 v[64:79], v[100:103], v[104:107], v[64:79]
    buffer_load_dwordx4 v7, s[56:59], s18 offen offset:1024 lds
    ds_read_b128 v[124:127], v19 offset:36864
    v_mfma_f32_32x32x16_bf16 v[80:95], v[100:103], v[108:111], v[80:95]
    s_waitcnt lgkmcnt(4)
    v_mfma_f32_32x32x16_bf16 v[232:247], v[248:251], v[112:115], v[232:247]
    ds_read_b64_tr_b16 v[96:97], v10 offset:16384
    ds_read_b64_tr_b16 v[98:99], v10 offset:17408
    s_waitcnt lgkmcnt(3)
    v_mfma_f32_32x32x16_bf16 v[32:47], v[112:115], v[120:123], v[32:47]
    s_add_u32 m0, s84, 24576
    s_nop 0
    buffer_load_dwordx4 v4, s[52:55], s10 offen lds
    ds_read_b64_tr_b16 v[100:101], v11 offset:16384
    s_waitcnt lgkmcnt(3)
    v_mfma_f32_32x32x16_bf16 v[48:63], v[112:115], v[124:127], v[48:63]
    ds_read_b64_tr_b16 v[102:103], v11 offset:17408
    ds_read_b128 v[104:107], v16 offset:0
    v_mfma_f32_32x32x16_bf16 v[64:79], v[116:119], v[120:123], v[64:79]
    buffer_load_dwordx4 v5, s[52:55], s10 offen offset:1024 lds
    ds_read_b128 v[108:111], v16 offset:4096
    v_mfma_f32_32x32x16_bf16 v[80:95], v[116:119], v[124:127], v[80:95]
    s_waitcnt vmcnt(6)
    s_barrier
    s_waitcnt lgkmcnt(4)
    v_mfma_f32_32x32x16_bf16 v[232:247], v[248:251], v[96:99], v[232:247]
    ds_read_b64_tr_b16 v[112:113], v10 offset:20480
    ds_read_b64_tr_b16 v[114:115], v10 offset:21504
    s_waitcnt lgkmcnt(3)
    v_mfma_f32_32x32x16_bf16 v[32:47], v[96:99], v[104:107], v[32:47]
    s_add_u32 m0, s84, 57344
    s_nop 0
    buffer_load_dwordx4 v8, s[56:59], s18 offen lds
    ds_read_b64_tr_b16 v[116:117], v11 offset:20480
    s_waitcnt lgkmcnt(3)
    v_mfma_f32_32x32x16_bf16 v[48:63], v[96:99], v[108:111], v[48:63]
    ds_read_b64_tr_b16 v[118:119], v11 offset:21504
    ds_read_b128 v[120:123], v17 offset:0
    v_mfma_f32_32x32x16_bf16 v[64:79], v[100:103], v[104:107], v[64:79]
    buffer_load_dwordx4 v9, s[56:59], s18 offen offset:1024 lds
    ds_read_b128 v[124:127], v17 offset:4096
    v_mfma_f32_32x32x16_bf16 v[80:95], v[100:103], v[108:111], v[80:95]
    s_waitcnt lgkmcnt(4)
    v_mfma_f32_32x32x16_bf16 v[232:247], v[248:251], v[112:115], v[232:247]
    ds_read_b64_tr_b16 v[96:97], v10 offset:24576
    ds_read_b64_tr_b16 v[98:99], v10 offset:25600
    s_waitcnt lgkmcnt(3)
    v_mfma_f32_32x32x16_bf16 v[32:47], v[112:115], v[120:123], v[32:47]
    s_add_u32 m0, s84, 32768
    s_nop 0
    buffer_load_dwordx4 v2, s[52:55], s11 offen lds
    ds_read_b64_tr_b16 v[100:101], v11 offset:24576
    s_waitcnt lgkmcnt(3)
    v_mfma_f32_32x32x16_bf16 v[48:63], v[112:115], v[124:127], v[48:63]
    ds_read_b64_tr_b16 v[102:103], v11 offset:25600
    ds_read_b128 v[104:107], v18 offset:0
    v_mfma_f32_32x32x16_bf16 v[64:79], v[116:119], v[120:123], v[64:79]
    buffer_load_dwordx4 v3, s[52:55], s11 offen offset:1024 lds
    ds_read_b128 v[108:111], v18 offset:4096
    v_mfma_f32_32x32x16_bf16 v[80:95], v[116:119], v[124:127], v[80:95]
    s_waitcnt vmcnt(4)
    s_barrier
    s_mov_b64 exec, 0x1
    v_cmp_eq_u32 vcc, 1, v31
    s_mov_b64 s[46:47], exec
    s_mov_b64 exec, -1
    s_nop 1
    s_cmp_eq_u64 vcc, s[46:47]
    s_cbranch_scc0 L_g1_rdy_slow
L_g1_rdy_back:
    s_waitcnt lgkmcnt(4)
    v_mfma_f32_32x32x16_bf16 v[232:247], v[248:251], v[96:99], v[232:247]
    ds_read_b64_tr_b16 v[112:113], v10 offset:28672
    ds_read_b64_tr_b16 v[114:115], v10 offset:29696
    s_waitcnt lgkmcnt(3)
    v_mfma_f32_32x32x16_bf16 v[32:47], v[96:99], v[104:107], v[32:47]
    s_add_u32 m0, s84, 65536
    s_nop 0
    buffer_load_dwordx4 v6, s[56:59], s19 offen lds
    ds_read_b64_tr_b16 v[116:117], v11 offset:28672
    s_waitcnt lgkmcnt(3)
    v_mfma_f32_32x32x16_bf16 v[48:63], v[96:99], v[108:111], v[48:63]
    ds_read_b64_tr_b16 v[118:119], v11 offset:29696
    ds_read_b128 v[120:123], v19 offset:0
    v_mfma_f32_32x32x16_bf16 v[64:79], v[100:103], v[104:107], v[64:79]
    buffer_load_dwordx4 v7, s[56:59], s19 offen offset:1024 lds
    ds_read_b128 v[124:127], v19 offset:4096
    v_mfma_f32_32x32x16_bf16 v[80:95], v[100:103], v[108:111], v[80:95]
    s_waitcnt lgkmcnt(4)
    v_mfma_f32_32x32x16_bf16 v[232:247], v[248:251], v[112:115], v[232:247]
    ds_read_b64_tr_b16 v[96:97], v10 offset:0
    ds_read_b64_tr_b16 v[98:99], v10 offset:1024
    s_waitcnt lgkmcnt(3)
    v_mfma_f32_32x32x16_bf16 v[32:47], v[112:115], v[120:123], v[32:47]
    s_add_u32 m0, s84, 40960
    s_nop 0
    buffer_load_dwordx4 v4, s[52:55], s11 offen lds
    ds_read_b64_tr_b16 v[100:101], v11 offset:0
    s_waitcnt lgkmcnt(3)
    v_mfma_f32_32x32x16_bf16 v[48:63], v[112:115], v[124:127], v[48:63]
    ds_read_b64_tr_b16 v[102:103], v11 offset:1024
    ds_read_b128 v[104:107], v16 offset:16384
    v_mfma_f32_32x32x16_bf16 v[64:79], v[116:119], v[120:123], v[64:79]
    buffer_load_dwordx4 v5, s[52:55], s11 offen offset:1024 lds
    ds_read_b128 v[108:111], v16 offset:20480
    v_mfma_f32_32x32x16_bf16 v[80:95], v[116:119], v[124:127], v[80:95]
    s_waitcnt vmcnt(6)
    s_barrier
    s_mov_b64 exec, 0xffff
    buffer_load_dword v31, v29, s[64:67], 0 offen offset:0 sc1
    s_mov_b64 exec, -1
    s_waitcnt lgkmcnt(4)
    v_mfma_f32_32x32x16_bf16 v[232:247], v[248:251], v[96:99], v[232:247]
    ds_read_b64_tr_b16 v[112:113], v10 offset:4096
    ds_read_b64_tr_b16 v[114:115], v10 offset:5120
    s_waitcnt lgkmcnt(3)
    v_mfma_f32_32x32x16_bf16 v[32:47], v[96:99], v[104:107], v[32:47]
    s_add_u32 m0, s84, 73728
    s_nop 0
    buffer_load_dwordx4 v8, s[56:59], s19 offen lds
    ds_read_b64_tr_b16 v[116:117], v11 offset:4096
    s_waitcnt lgkmcnt(3)
    v_mfma_f32_32x32x16_bf16 v[48:63], v[96:99], v[108:111], v[48:63]
    ds_read_b64_tr_b16 v[118:119], v11 offset:5120
    ds_read_b128 v[120:123], v17 offset:16384
    v_mfma_f32_32x32x16_bf16 v[64:79], v[100:103], v[104:107], v[64:79]
    buffer_load_dwordx4 v9, s[56:59], s19 offen offset:1024 lds
    ds_read_b128 v[124:127], v17 offset:20480
    v_mfma_f32_32x32x16_bf16 v[80:95], v[100:103], v[108:111], v[80:95]
    s_waitcnt lgkmcnt(4)
    v_mfma_f32_32x32x16_bf16 v[232:247], v[248:251], v[112:115], v[232:247]
    ds_read_b64_tr_b16 v[96:97], v10 offset:8192
    ds_read_b64_tr_b16 v[98:99], v10 offset:9216
    s_waitcnt lgkmcnt(3)
    v_mfma_f32_32x32x16_bf16 v[32:47], v[112:115], v[120:123], v[32:47]
    s_add_u32 m0, s84, 0
    s_nop 0
    buffer_load_dwordx4 v2, s[52:55], s12 offen lds
    ds_read_b64_tr_b16 v[100:101], v11 offset:8192
    s_waitcnt lgkmcnt(3)
    v_mfma_f32_32x32x16_bf16 v[48:63], v[112:115], v[124:127], v[48:63]
    ds_read_b64_tr_b16 v[102:103], v11 offset:9216
    ds_read_b128 v[104:107], v18 offset:16384
    v_mfma_f32_32x32x16_bf16 v[64:79], v[116:119], v[120:123], v[64:79]
    buffer_load_dwordx4 v3, s[52:55], s12 offen offset:1024 lds
    ds_read_b128 v[108:111], v18 offset:20480
    v_mfma_f32_32x32x16_bf16 v[80:95], v[116:119], v[124:127], v[80:95]
    s_waitcnt vmcnt(5)
    s_barrier
    s_waitcnt lgkmcnt(4)
    v_mfma_f32_32x32x16_bf16 v[232:247], v[248:251], v[96:99], v[232:247]
    ds_read_b64_tr_b16 v[112:113], v10 offset:12288
    ds_read_b64_tr_b16 v[114:115], v10 offset:13312
    s_waitcnt lgkmcnt(3)
    v_mfma_f32_32x32x16_bf16 v[32:47], v[96:99], v[104:107], v[32:47]
    s_add_u32 m0, s84, 49152
    s_nop 0
    buffer_load_dwordx4 v6, s[56:59], s20 offen lds
    ds_read_b64_tr_b16 v[116:117], v11 offset:12288
    s_waitcnt lgkmcnt(3)
    v_mfma_f32_32x32x16_bf16 v[48:63], v[96:99], v[108:111], v[48:63]
    ds_read_b64_tr_b16 v[118:119], v11 offset:13312
    ds_read_b128 v[120:123], v19 offset:16384
    v_mfma_f32_32x32x16_bf16 v[64:79], v[100:103], v[104:107], v[64:79]
    buffer_load_dwordx4 v7, s[56:59], s20 offen offset:1024 lds
    ds_read_b128 v[124:127], v19 offset:20480
    v_mfma_f32_32x32x16_bf16 v[80:95], v[100:103], v[108:111], v[80:95]
    s_waitcnt lgkmcnt(4)
    v_mfma_f32_32x32x16_bf16 v[232:247], v[248:251], v[112:115], v[232:247]
    ds_read_b64_tr_b16 v[96:97], v10 offset:16384
    ds_read_b64_tr_b16 v[98:99], v10 offset:17408
    s_waitcnt lgkmcnt(3)
    v_mfma_f32_32x32x16_bf16 v[32:47], v[112:115], v[120:123], v[32:47]
    s_add_u32 m0, s84, 8192
    s_nop 0
    buffer_load_dwordx4 v4, s[52:55], s12 offen lds
    ds_read_b64_tr_b16 v[100:101], v11 offset:16384
    s_waitcnt lgkmcnt(3)
    v_mfma_f32_32x32x16_bf16 v[48:63], v[112:115], v[124:127], v[48:63]
    ds_read_b64_tr_b16 v[102:103], v11 offset:17408
    ds_read_b128 v[104:107], v16 offset:32768
    v_mfma_f32_32x32x16_bf16 v[64:79], v[116:119], v[120:123], v[64:79]
    buffer_load_dwordx4 v5, s[52:55], s12 offen offset:1024 lds
    ds_read_b128 v[108:111], v16 offset:36864
    v_mfma_f32_32x32x16_bf16 v[80:95], v[116:119], v[124:127], v[80:95]
    s_waitcnt vmcnt(6)
    s_barrier
    s_waitcnt lgkmcnt(4)
    v_mfma_f32_32x32x16_bf16 v[232:247], v[248:251], v[96:99], v[232:247]
    ds_read_b64_tr_b16 v[112:113], v10 offset:20480
    ds_read_b64_tr_b16 v[114:115], v10 offset:21504
    s_waitcnt lgkmcnt(3)
    v_mfma_f32_32x32x16_bf16 v[32:47], v[96:99], v[104:107], v[32:47]
    s_add_u32 m0, s84, 57344
    s_nop 0
    buffer_load_dwordx4 v8, s[56:59], s20 offen lds
    ds_read_b64_tr_b16 v[116:117], v11 offset:20480
    s_waitcnt lgkmcnt(3)
    v_mfma_f32_32x32x16_bf16 v[48:63], v[96:99], v[108:111], v[48:63]
    ds_read_b64_tr_b16 v[118:119], v11 offset:21504
    ds_read_b128 v[120:123], v17 offset:32768
    v_mfma_f32_32x32x16_bf16 v[64:79], v[100:103], v[104:107], v[64:79]
    buffer_load_dwordx4 v9, s[56:59], s20 offen offset:1024 lds
    ds_read_b128 v[124:127], v17 offset:36864
    v_mfma_f32_32x32x16_bf16 v[80:95], v[100:103], v[108:111], v[80:95]
    s_waitcnt lgkmcnt(4)
    v_mfma_f32_32x32x16_bf16 v[232:247], v[248:251], v[112:115], v[232:247]
    ds_read_b64_tr_b16 v[96:97], v10 offset:24576
    ds_read_b64_tr_b16 v[98:99], v10 offset:25600
    s_waitcnt lgkmcnt(3)
    v_mfma_f32_32x32x16_bf16 v[32:47], v[112:115], v[120:123], v[32:47]
    s_add_u32 m0, s84, 16384
    s_nop 0
    buffer_load_dwordx4 v2, s[52:55], s13 offen lds
    ds_read_b64_tr_b16 v[100:101], v11 offset:24576
    s_waitcnt lgkmcnt(3)
    v_mfma_f32_32x32x16_bf16 v[48:63], v[112:115], v[124:127], v[48:63]
    ds_read_b64_tr_b16 v[102:103], v11 offset:25600
    ds_read_b128 v[104:107], v18 offset:32768
    v_mfma_f32_32x32x16_bf16 v[64:79], v[116:119], v[120:123], v[64:79]
    buffer_load_dwordx4 v3, s[52:55], s13 offen offset:1024 lds
    ds_read_b128 v[108:111], v18 offset:36864
    v_mfma_f32_32x32x16_bf16 v[80:95], v[116:119], v[124:127], v[80:95]
    s_waitcnt vmcnt(4)
    s_barrier
    s_mov_b64 exec, 0xffff
    v_cmp_eq_u32 vcc, 1, v31
    s_mov_b64 s[46:47], exec
    s_mov_b64 exec, -1
    s_nop 1
    s_cmp_eq_u64 vcc, s[46:47]
    s_cbranch_scc0 L_g1_fl_slow
L_g1_fl_back:
    buffer_load_dwordx2 v[12:13], v30, s[48:51], 0 offen offset:0 sc1
    buffer_load_dwordx2 v[14:15], v30, s[48:51], 0 offen offset:256 sc1
    s_waitcnt lgkmcnt(4)
    v_mfma_f32_32x32x16_bf16 v[232:247], v[248:251], v[96:99], v[232:247]
    ds_read_b64_tr_b16 v[112:113], v10 offset:28672
    ds_read_b64_tr_b16 v[114:115], v10 offset:29696
    s_waitcnt lgkmcnt(3)
    v_mfma_f32_32x32x16_bf16 v[32:47], v[96:99], v[104:107], v[32:47]
    s_add_u32 m0, s84, 65536
    s_nop 0
    buffer_load_dwordx4 v6, s[56:59], s21 offen lds
    ds_read_b64_tr_b16 v[116:117], v11 offset:28672
    s_waitcnt lgkmcnt(3)
    v_mfma_f32_32x32x16_bf16 v[48:63], v[96:99], v[108:111], v[48:63]
    ds_read_b64_tr_b16 v[118:119], v11 offset:29696
    ds_read_b128 v[120:123], v19 offset:32768
    v_mfma_f32_32x32x16_bf16 v[64:79], v[100:103], v[104:107], v[64:79]
    buffer_load_dwordx4 v7, s[56:59], s21 offen offset:1024 lds
    ds_read_b128 v[124:127], v19 offset:36864
    v_mfma_f32_32x32x16_bf16 v[80:95], v[100:103], v[108:111], v[80:95]
    s_waitcnt lgkmcnt(4)
    v_mfma_f32_32x32x16_bf16 v[232:247], v[248:251], v[112:115], v[232:247]
    ds_read_b64_tr_b16 v[96:97], v10 offset:0
    ds_read_b64_tr_b16 v[98:99], v10 offset:1024
    s_waitcnt lgkmcnt(3)
    v_mfma_f32_32x32x16_bf16 v[32:47], v[112:115], v[120:123], v[32:47]
    s_add_u32 m0, s84, 24576
    s_nop 0
    buffer_load_dwordx4 v4, s[52:55], s13 offen lds
    ds_read_b64_tr_b16 v[100:101], v11 offset:0
    s_waitcnt lgkmcnt(3)
    v_mfma_f32_32x32x16_bf16 v[48:63], v[112:115], v[124:127], v[48:63]
    ds_read_b64_tr_b16 v[102:103], v11 offset:1024
    ds_read_b128 v[104:107], v16 offset:0
    v_mfma_f32_32x32x16_bf16 v[64:79], v[116:119], v[120:123], v[64:79]
    buffer_load_dwordx4 v5, s[52:55], s13 offen offset:1024 lds
    ds_read_b128 v[108:111], v16 offset:4096
    v_mfma_f32_32x32x16_bf16 v[80:95], v[116:119], v[124:127], v[80:95]
    s_waitcnt vmcnt(8)
    s_barrier
    s_waitcnt lgkmcnt(4)
    v_mfma_f32_32x32x16_bf16 v[232:247], v[248:251], v[96:99], v[232:247]
    ds_read_b64_tr_b16 v[112:113], v10 offset:4096
    ds_read_b64_tr_b16 v[114:115], v10 offset:5120
    s_waitcnt lgkmcnt(3)
    v_mfma_f32_32x32x16_bf16 v[32:47], v[96:99], v[104:107], v[32:47]
    s_add_u32 m0, s84, 73728
    s_nop 0
    buffer_load_dwordx4 v8, s[56:59], s21 offen lds
    ds_read_b64_tr_b16 v[116:117], v11 offset:4096
    s_waitcnt lgkmcnt(3)
    v_mfma_f32_32x32x16_bf16 v[48:63], v[96:99], v[108:111], v[48:63]
    ds_read_b64_tr_b16 v[118:119], v11 offset:5120
    ds_read_b128 v[120:123], v17 offset:0
    v_mfma_f32_32x32x16_bf16 v[64:79], v[100:103], v[104:107], v[64:79]
    buffer_load_dwordx4 v9, s[56:59], s21 offen offset:1024 lds
    ds_read_b128 v[124:127], v17 offset:4096
    v_mfma_f32_32x32x16_bf16 v[80:95], v[100:103], v[108:111], v[80:95]
    s_waitcnt lgkmcnt(4)
    v_mfma_f32_32x32x16_bf16 v[232:247], v[248:251], v[112:115], v[232:247]
    ds_read_b64_tr_b16 v[96:97], v10 offset:8192
    ds_read_b64_tr_b16 v[98:99], v10 offset:9216
    s_add_u32 m0, s81, 32768
    s_lshl4_add_u32 s89, s90, s97
    s_waitcnt lgkmcnt(3)
    v_mfma_f32_32x32x16_bf16 v[32:47], v[112:115], v[120:123], v[32:47]
    ds_read_b64_tr_b16 v[100:101], v11 offset:8192
    ds_read_b64_tr_b16 v[102:103], v11 offset:9216
    buffer_load_dwordx4 v128, s[24:27], s89 offen lds
    buffer_load_dwordx4 v129, s[24:27], s89 offen offset:1024 lds
    s_waitcnt lgkmcnt(4)
    v_mfma_f32_32x32x16_bf16 v[48:63], v[112:115], v[124:127], v[48:63]
    ds_read_b128 v[104:107], v18 offset:0
    ds_read_b128 v[108:111], v18 offset:4096
    s_add_u32 m0, s81, 34816
    s_lshl4_add_u32 s89, s91, s97
    v_mfma_f32_32x32x16_bf16 v[64:79], v[116:119], v[120:123], v[64:79]
    buffer_load_dwordx4 v128, s[24:27], s89 offen lds
    buffer_load_dwordx4 v129, s[24:27], s89 offen offset:1024 lds
    v_mfma_f32_32x32x16_bf16 v[80:95], v[116:119], v[124:127], v[80:95]
    s_waitcnt vmcnt(6)
    s_barrier
    s_waitcnt lgkmcnt(4)
    v_mfma_f32_32x32x16_bf16 v[232:247], v[248:251], v[96:99], v[232:247]
    ds_read_b64_tr_b16 v[112:113], v10 offset:12288
    ds_read_b64_tr_b16 v[114:115], v10 offset:13312
    s_add_u32 m0, s80, 49152
    s_waitcnt lgkmcnt(3)
    v_mfma_f32_32x32x16_bf16 v[32:47], v[96:99], v[104:107], v[32:47]
    ds_read_b64_tr_b16 v[116:117], v11 offset:12288
    ds_read_b64_tr_b16 v[118:119], v11 offset:13312
    s_lshl4_add_u32 s89, s92, s97
    s_waitcnt lgkmcnt(4)
    v_mfma_f32_32x32x16_bf16 v[48:63], v[96:99], v[108:111], v[48:63]
    ds_read_b128 v[120:123], v19 offset:0
    ds_read_b128 v[124:127], v19 offset:4096
    buffer_load_dwordx4 v128, s[24:27], s89 offen lds
    v_mfma_f32_32x32x16_bf16 v[64:79], v[100:103], v[104:107], v[64:79]
    buffer_load_dwordx4 v129, s[24:27], s89 offen offset:1024 lds
    v_mfma_f32_32x32x16_bf16 v[80:95], v[100:103], v[108:111], v[80:95]
    s_waitcnt lgkmcnt(4)
    v_mfma_f32_32x32x16_bf16 v[232:247], v[248:251], v[112:115], v[232:247]
    ds_read_b64_tr_b16 v[96:97], v10 offset:16384
    ds_read_b64_tr_b16 v[98:99], v10 offset:17408
    s_waitcnt lgkmcnt(3)
    v_mfma_f32_32x32x16_bf16 v[32:47], v[112:115], v[120:123], v[32:47]
    ds_read_b64_tr_b16 v[100:101], v11 offset:16384
    s_waitcnt lgkmcnt(3)
    v_mfma_f32_32x32x16_bf16 v[48:63], v[112:115], v[124:127], v[48:63]
    ds_read_b64_tr_b16 v[102:103], v11 offset:17408
    ds_read_b128 v[104:107], v16 offset:16384
    v_mfma_f32_32x32x16_bf16 v[64:79], v[116:119], v[120:123], v[64:79]
    ds_read_b128 v[108:111], v16 offset:20480
    v_mfma_f32_32x32x16_bf16 v[80:95], v[116:119], v[124:127], v[80:95]
    s_waitcnt vmcnt(6)
    s_barrier
    s_mov_b32 s42, 0xffff0000
    v_cmp_gt_u32 vcc, 32, v1
    v_xor_b32 v22, 0x80000000, v12
    v_lshrrev_b32 v220, 16, v13
    v_and_or_b32 v220, v22, s42, v220
    v_lshrrev_b32 v221, 16, v22
    v_and_or_b32 v221, v22, s42, v221
    v_cndmask_b32 v220, 0, v220, vcc
    v_cndmask_b32 v221, 0, v221, vcc
    v_mov_b32 v222, 0
    v_mov_b32 v223, 0
    v_rcp_f32 v22, v13
    s_nop 0
    v_mul_f32 v28, 0xc0135761, v22
    v_mul_f32 v22, v22, v22
    v_mul_f32 v22, v22, v28
    v_mul_f32 v30, 0x3d372713, v22
    s_waitcnt lgkmcnt(4)
    v_mfma_f32_32x32x16_bf16 v[232:247], v[248:251], v[96:99], v[232:247]
    ds_read_b64_tr_b16 v[112:113], v10 offset:20480
    ds_read_b64_tr_b16 v[114:115], v10 offset:21504
    s_add_u32 m0, s81, 0
    s_lshl4_add_u32 s89, s93, s97
    s_waitcnt lgkmcnt(3)
    v_mfma_f32_32x32x16_bf16 v[32:47], v[96:99], v[104:107], v[32:47]
    ds_read_b64_tr_b16 v[116:117], v11 offset:20480
    ds_read_b64_tr_b16 v[118:119], v11 offset:21504
    buffer_load_dwordx4 v128, s[24:27], s89 offen lds
    buffer_load_dwordx4 v129, s[24:27], s89 offen offset:1024 lds
    s_waitcnt lgkmcnt(4)
    v_mfma_f32_32x32x16_bf16 v[48:63], v[96:99], v[108:111], v[48:63]
    ds_read_b128 v[120:123], v17 offset:16384
    ds_read_b128 v[124:127], v17 offset:20480
    s_add_u32 m0, s81, 2048
    s_lshl4_add_u32 s89, s94, s97
    v_mfma_f32_32x32x16_bf16 v[64:79], v[100:103], v[104:107], v[64:79]
    buffer_load_dwordx4 v128, s[24:27], s89 offen lds
    buffer_load_dwordx4 v129, s[24:27], s89 offen offset:1024 lds
    v_mfma_f32_32x32x16_bf16 v[80:95], v[100:103], v[108:111], v[80:95]
    s_waitcnt lgkmcnt(4)
    v_mfma_f32_32x32x16_bf16 v[232:247], v[248:251], v[112:115], v[232:247]
    ds_read_b64_tr_b16 v[96:97], v10 offset:24576
    ds_read_b64_tr_b16 v[98:99], v10 offset:25600
    s_add_u32 m0, s80, 57344
    s_waitcnt lgkmcnt(3)
    v_mfma_f32_32x32x16_bf16 v[32:47], v[112:115], v[120:123], v[32:47]
    ds_read_b64_tr_b16 v[100:101], v11 offset:24576
    ds_read_b64_tr_b16 v[102:103], v11 offset:25600
    s_lshl4_add_u32 s89, s95, s97
    s_waitcnt lgkmcnt(4)
    v_mfma_f32_32x32x16_bf16 v[48:63], v[112:115], v[124:127], v[48:63]
    ds_read_b128 v[104:107], v18 offset:16384
    ds_read_b128 v[108:111], v18 offset:20480
    buffer_load_dwordx4 v128, s[24:27], s89 offen lds
    v_mfma_f32_32x32x16_bf16 v[64:79], v[116:119], v[120:123], v[64:79]
    buffer_load_dwordx4 v129, s[24:27], s89 offen offset:1024 lds
    v_mfma_f32_32x32x16_bf16 v[80:95], v[116:119], v[124:127], v[80:95]
    s_barrier
    s_mov_b32 s42, 0xffff0000
    v_cmp_gt_u32 vcc, 32, v1
    v_xor_b32 v22, 0x80000000, v14
    v_lshrrev_b32 v224, 16, v15
    v_and_or_b32 v224, v22, s42, v224
    v_lshrrev_b32 v225, 16, v22
    v_and_or_b32 v225, v22, s42, v225
    v_cndmask_b32 v224, 0, v224, vcc
    v_cndmask_b32 v225, 0, v225, vcc
    v_mov_b32 v226, 0
    v_mov_b32 v227, 0
    v_rcp_f32 v22, v15
    s_nop 0
    v_mul_f32 v29, 0xc0135761, v22
    v_mul_f32 v22, v22, v22
    v_mul_f32 v22, v22, v29
    v_mul_f32 v31, 0x3d372713, v22
    s_waitcnt lgkmcnt(4)
    v_mfma_f32_32x32x16_bf16 v[232:247], v[248:251], v[96:99], v[232:247]
    ds_read_b64_tr_b16 v[112:113], v10 offset:28672
    ds_read_b64_tr_b16 v[114:115], v10 offset:29696
    s_waitcnt lgkmcnt(3)
    v_mfma_f32_32x32x16_bf16 v[32:47], v[96:99], v[104:107], v[32:47]
    ds_read_b64_tr_b16 v[116:117], v11 offset:28672
    s_waitcnt lgkmcnt(3)
    v_mfma_f32_32x32x16_bf16 v[48:63], v[96:99], v[108:111], v[48:63]
    ds_read_b64_tr_b16 v[118:119], v11 offset:29696
    ds_read_b128 v[120:123], v19 offset:16384
    v_mfma_f32_32x32x16_bf16 v[64:79], v[100:103], v[104:107], v[64:79]
    ds_read_b128 v[124:127], v19 offset:20480
    v_mfma_f32_32x32x16_bf16 v[80:95], v[100:103], v[108:111], v[80:95]
    s_waitcnt lgkmcnt(4)
    v_mfma_f32_32x32x16_bf16 v[232:247], v[248:251], v[112:115], v[232:247]
    s_waitcnt lgkmcnt(1)
    v_mfma_f32_32x32x16_bf16 v[32:47], v[112:115], v[120:123], v[32:47]
    s_waitcnt lgkmcnt(0)
    v_mfma_f32_32x32x16_bf16 v[48:63], v[112:115], v[124:127], v[48:63]
    v_mfma_f32_32x32x16_bf16 v[64:79], v[116:119], v[120:123], v[64:79]
    v_mfma_f32_32x32x16_bf16 v[80:95], v[116:119], v[124:127], v[80:95]
    s_nop 5
    ds_write_b32 v23, v232
    v_cmp_gt_u32 vcc, 32, v1
    v_cvt_pk_bf16_f32 v104, v232, v232
    v_lshlrev_b32 v104, 16, v104
    v_sub_f32 v22, v232, v104
    v_cvt_pk_bf16_f32 v106, v22, v22
    v_lshlrev_b32 v106, 16, v106
    v_sub_f32 v106, v22, v106
    v_cvt_pk_bf16_f32 v105, v22, v106
    v_or_b32 v104, v104, v26
    v_cndmask_b32 v104, 0, v104, vcc
    v_cndmask_b32 v105, 0, v105, vcc
    v_mov_b32 v106, 0
    v_mov_b32 v107, 0
    s_nop 1
    v_mfma_f32_32x32x16_bf16 v[32:47], v[104:107], v[220:223], v[32:47]
    v_mfma_f32_32x32x16_bf16 v[48:63], v[104:107], v[224:227], v[48:63]
    s_waitcnt lgkmcnt(0)
    s_barrier
    ds_read_b32 v233, v21
    s_add_u32 m0, s81, 16384
    s_lshl4_add_u32 s89, s90, s98
    buffer_load_dwordx4 v128, s[24:27], s89 offen lds
    buffer_load_dwordx4 v129, s[24:27], s89 offen offset:1024 lds
    s_add_u32 m0, s81, 18432
    s_lshl4_add_u32 s89, s91, s98
    buffer_load_dwordx4 v128, s[24:27], s89 offen lds
    buffer_load_dwordx4 v129, s[24:27], s89 offen offset:1024 lds
    s_add_u32 m0, s80, 73728
    s_lshl4_add_u32 s89, s92, s98
    buffer_load_dwordx4 v128, s[24:27], s89 offen lds
    buffer_load_dwordx4 v129, s[24:27], s89 offen offset:1024 lds
    s_waitcnt lgkmcnt(0)
    s_add_u32 m0, s80, 65536
    s_lshl4_add_u32 s89, s96, s97
    buffer_load_dwordx4 v128, s[24:27], s89 offen lds
    buffer_load_dwordx4 v129, s[24:27], s89 offen offset:1024 lds
    v_cmp_gt_u32 vcc, 32, v1
    v_cvt_pk_bf16_f32 v228, v233, v233
    v_lshlrev_b32 v228, 16, v228
    v_sub_f32 v22, v233, v228
    v_cvt_pk_bf16_f32 v230, v22, v22
    v_lshlrev_b32 v230, 16, v230
    v_sub_f32 v230, v22, v230
    v_cvt_pk_bf16_f32 v229, v22, v230
    v_or_b32 v228, v228, v27
    v_cndmask_b32 v228, 0, v228, vcc
    v_cndmask_b32 v229, 0, v229, vcc
    v_mov_b32 v230, 0
    v_mov_b32 v231, 0
    s_nop 1
    v_mfma_f32_32x32x16_bf16 v[64:79], v[228:231], v[220:223], v[64:79]
    v_mfma_f32_32x32x16_bf16 v[80:95], v[228:231], v[224:227], v[80:95]
    s_mul_i32 s42, s72, 14
    s_add_u32 s42, s42, s73
    s_lshl_b32 s42, s42, 6
    s_lshl_b32 s43, s40, 2
    s_add_u32 s42, s42, s43
    s_add_u32 s42, s42, 16384
    v_mov_b32 v26, s42
    v_mov_b32 v27, 1
    s_mov_b32 s101, 0
    v_mul_f32 v96, v32, v32
    v_mul_f32 v97, v33, v33
    v_mul_f32 v98, v34, v34
    v_mul_f32 v99, v35, v35
    v_mul_f32 v100, v36, v36
    v_mul_f32 v101, v37, v37
    v_mul_f32 v102, v38, v38
    v_mul_f32 v103, v39, v39
    v_fma_f32 v96, v96, v30, v28
    v_fma_f32 v97, v97, v30, v28
    v_fma_f32 v98, v98, v30, v28
    v_fma_f32 v99, v99, v30, v28
    v_fma_f32 v100, v100, v30, v28
    v_fma_f32 v101, v101, v30, v28
    v_fma_f32 v102, v102, v30, v28
    v_fma_f32 v103, v103, v30, v28
    v_mul_f32 v96, v96, v32
    v_mul_f32 v97, v97, v33
    v_mul_f32 v98, v98, v34
    v_mul_f32 v99, v99, v35
    v_mul_f32 v100, v100, v36
    v_mul_f32 v101, v101, v37
    v_mul_f32 v102, v102, v38
    v_mul_f32 v103, v103, v39
    v_exp_f32 v96, v96
    v_exp_f32 v97, v97
    v_exp_f32 v98, v98
    v_exp_f32 v99, v99
    v_exp_f32 v100, v100
    v_exp_f32 v101, v101
    v_exp_f32 v102, v102
    v_exp_f32 v103, v103
    v_fma_f32 v96, v96, v13, v13
    v_fma_f32 v97, v97, v13, v13
    v_fma_f32 v98, v98, v13, v13
    v_fma_f32 v99, v99, v13, v13
    v_fma_f32 v100, v100, v13, v13
    v_fma_f32 v101, v101, v13, v13
    v_fma_f32 v102, v102, v13, v13
    v_fma_f32 v103, v103, v13, v13
    v_rcp_f32 v96, v96
    v_rcp_f32 v97, v97
    v_rcp_f32 v98, v98
    v_rcp_f32 v99, v99
    v_rcp_f32 v100, v100
    v_rcp_f32 v101, v101
    v_rcp_f32 v102, v102
    v_rcp_f32 v103, v103
    v_mul_f32 v96, v96, v32
    v_mul_f32 v97, v97, v33
    v_mul_f32 v98, v98, v34
    v_mul_f32 v99, v99, v35
    v_mul_f32 v100, v100, v36
    v_mul_f32 v101, v101, v37
    v_mul_f32 v102, v102, v38
    v_mul_f32 v103, v103, v39
    v_cvt_pk_bf16_f32 v104, v96, v97
    v_cvt_pk_bf16_f32 v105, v98, v99
    v_cvt_pk_bf16_f32 v106, v100, v101
    v_cvt_pk_bf16_f32 v107, v102, v103
    buffer_store_dwordx4 v[104:107], v24, s[48:51], s77 offen offset:0 sc1
    v_mul_f32 v96, v48, v48
    v_mul_f32 v97, v49, v49
    v_mul_f32 v98, v50, v50
    v_mul_f32 v99, v51, v51
    v_mul_f32 v100, v52, v52
    v_mul_f32 v101, v53, v53
    v_mul_f32 v102, v54, v54
    v_mul_f32 v103, v55, v55
    v_fma_f32 v96, v96, v31, v29
    v_fma_f32 v97, v97, v31, v29
    v_fma_f32 v98, v98, v31, v29
    v_fma_f32 v99, v99, v31, v29
    v_fma_f32 v100, v100, v31, v29
    v_fma_f32 v101, v101, v31, v29
    v_fma_f32 v102, v102, v31, v29
    v_fma_f32 v103, v103, v31, v29
    v_mul_f32 v96, v96, v48
    v_mul_f32 v97, v97, v49
    v_mul_f32 v98, v98, v50
    v_mul_f32 v99, v99, v51
    v_mul_f32 v100, v100, v52
    v_mul_f32 v101, v101, v53
    v_mul_f32 v102, v102, v54
    v_mul_f32 v103, v103, v55
    v_exp_f32 v96, v96
    v_exp_f32 v97, v97
    v_exp_f32 v98, v98
    v_exp_f32 v99, v99
    v_exp_f32 v100, v100
    v_exp_f32 v101, v101
    v_exp_f32 v102, v102
    v_exp_f32 v103, v103
    v_fma_f32 v96, v96, v15, v15
    v_fma_f32 v97, v97, v15, v15
    v_fma_f32 v98, v98, v15, v15
    v_fma_f32 v99, v99, v15, v15
    v_fma_f32 v100, v100, v15, v15
    v_fma_f32 v101, v101, v15, v15
    v_fma_f32 v102, v102, v15, v15
    v_fma_f32 v103, v103, v15, v15
    v_rcp_f32 v96, v96
    v_rcp_f32 v97, v97
    v_rcp_f32 v98, v98
    v_rcp_f32 v99, v99
    v_rcp_f32 v100, v100
    v_rcp_f32 v101, v101
    v_rcp_f32 v102, v102
    v_rcp_f32 v103, v103
    v_mul_f32 v96, v96, v48
    v_mul_f32 v97, v97, v49
    v_mul_f32 v98, v98, v50
    v_mul_f32 v99, v99, v51
    v_mul_f32 v100, v100, v52
    v_mul_f32 v101, v101, v53
    v_mul_f32 v102, v102, v54
    v_mul_f32 v103, v103, v55
    v_cvt_pk_bf16_f32 v108, v96, v97
    v_cvt_pk_bf16_f32 v109, v98, v99
    v_cvt_pk_bf16_f32 v110, v100, v101
    v_cvt_pk_bf16_f32 v111, v102, v103
    buffer_store_dwordx4 v[108:111], v25, s[48:51], s77 offen offset:0 sc1
    s_waitcnt vmcnt(2)
    ds_read_b64_tr_b16 v[138:139], v130 offset:32768
    ds_read_b64_tr_b16 v[140:141], v130 offset:33792
    ds_read_b64_tr_b16 v[142:143], v131 offset:32768
    ds_read_b64_tr_b16 v[144:145], v131 offset:33792
    ds_read_b64_tr_b16 v[146:147], v130 offset:34816
    ds_read_b64_tr_b16 v[148:149], v130 offset:35840
    ds_read_b64_tr_b16 v[150:151], v131 offset:34816
    ds_read_b64_tr_b16 v[152:153], v131 offset:35840
    ds_read_b64_tr_b16 v[154:155], v218 offset:0
    ds_read_b64_tr_b16 v[156:157], v218 offset:1024
    ds_read_b64_tr_b16 v[158:159], v219 offset:0
    ds_read_b64_tr_b16 v[160:161], v219 offset:1024
    ds_read_b64_tr_b16 v[162:163], v130 offset:0
    ds_read_b64_tr_b16 v[164:165], v130 offset:1024
    ds_read_b64_tr_b16 v[166:167], v131 offset:0
    ds_read_b64_tr_b16 v[168:169], v131 offset:1024
    ds_read_b64_tr_b16 v[170:171], v130 offset:2048
    ds_read_b64_tr_b16 v[172:173], v130 offset:3072
    ds_read_b64_tr_b16 v[174:175], v131 offset:2048
    ds_read_b64_tr_b16 v[176:177], v131 offset:3072
    ds_read_b64_tr_b16 v[178:179], v218 offset:8192
    ds_read_b64_tr_b16 v[180:181], v218 offset:9216
    ds_read_b64_tr_b16 v[182:183], v219 offset:8192
    ds_read_b64_tr_b16 v[184:185], v219 offset:9216
    ds_read_b64_tr_b16 v[186:187], v218 offset:16384
    ds_read_b64_tr_b16 v[188:189], v218 offset:17408
    ds_read_b64_tr_b16 v[190:191], v219 offset:16384
    ds_read_b64_tr_b16 v[192:193], v219 offset:17408
    ds_read_b64_tr_b16 v[194:195], v130 offset:16384
    ds_read_b64_tr_b16 v[196:197], v130 offset:17408
    ds_read_b64_tr_b16 v[198:199], v131 offset:16384
    ds_read_b64_tr_b16 v[200:201], v131 offset:17408
    ds_read_b64_tr_b16 v[202:203], v130 offset:18432
    ds_read_b64_tr_b16 v[204:205], v130 offset:19456
    ds_read_b64_tr_b16 v[206:207], v131 offset:18432
    ds_read_b64_tr_b16 v[208:209], v131 offset:19456
    ds_read_b64_tr_b16 v[210:211], v218 offset:24576
    ds_read_b64_tr_b16 v[212:213], v218 offset:25600
    ds_read_b64_tr_b16 v[214:215], v219 offset:24576
    ds_read_b64_tr_b16 v[216:217], v219 offset:25600
    s_waitcnt lgkmcnt(0)
    v_mul_f32 v96, v40, v40
    v_mul_f32 v97, v41, v41
    v_mul_f32 v98, v42, v42
    v_mul_f32 v99, v43, v43
    v_mul_f32 v100, v44, v44
    v_mul_f32 v101, v45, v45
    v_mul_f32 v102, v46, v46
    v_mul_f32 v103, v47, v47
    v_fma_f32 v96, v96, v30, v28
    v_fma_f32 v97, v97, v30, v28
    v_fma_f32 v98, v98, v30, v28
    v_fma_f32 v99, v99, v30, v28
    v_fma_f32 v100, v100, v30, v28
    v_fma_f32 v101, v101, v30, v28
    v_fma_f32 v102, v102, v30, v28
    v_fma_f32 v103, v103, v30, v28
    v_mul_f32 v96, v96, v40
    v_mul_f32 v97, v97, v41
    v_mul_f32 v98, v98, v42
    v_mul_f32 v99, v99, v43
    v_mul_f32 v100, v100, v44
    v_mul_f32 v101, v101, v45
    v_mul_f32 v102, v102, v46
    v_mul_f32 v103, v103, v47
    v_exp_f32 v96, v96
    v_exp_f32 v97, v97
    v_exp_f32 v98, v98
    v_exp_f32 v99, v99
    v_exp_f32 v100, v100
    v_exp_f32 v101, v101
    v_exp_f32 v102, v102
    v_exp_f32 v103, v103
    v_fma_f32 v96, v96, v13, v13
    v_fma_f32 v97, v97, v13, v13
    v_fma_f32 v98, v98, v13, v13
    v_fma_f32 v99, v99, v13, v13
    v_fma_f32 v100, v100, v13, v13
    v_fma_f32 v101, v101, v13, v13
    v_fma_f32 v102, v102, v13, v13
    v_fma_f32 v103, v103, v13, v13
    v_rcp_f32 v96, v96
    v_rcp_f32 v97, v97
    v_rcp_f32 v98, v98
    v_rcp_f32 v99, v99
    v_rcp_f32 v100, v100
    v_rcp_f32 v101, v101
    v_rcp_f32 v102, v102
    v_rcp_f32 v103, v103
    v_mul_f32 v96, v96, v40
    v_mul_f32 v97, v97, v41
    v_mul_f32 v98, v98, v42
    v_mul_f32 v99, v99, v43
    v_mul_f32 v100, v100, v44
    v_mul_f32 v101, v101, v45
    v_mul_f32 v102, v102, v46
    v_mul_f32 v103, v103, v47
    v_cvt_pk_bf16_f32 v112, v96, v97
    v_cvt_pk_bf16_f32 v113, v98, v99
    v_cvt_pk_bf16_f32 v114, v100, v101
    v_cvt_pk_bf16_f32 v115, v102, v103
    buffer_store_dwordx4 v[112:115], v24, s[48:51], s77 offen offset:1024 sc1
    v_mul_f32 v96, v56, v56
    v_mul_f32 v97, v57, v57
    v_mul_f32 v98, v58, v58
    v_mul_f32 v99, v59, v59
    v_mul_f32 v100, v60, v60
    v_mul_f32 v101, v61, v61
    v_mul_f32 v102, v62, v62
    v_mul_f32 v103, v63, v63
    v_fma_f32 v96, v96, v31, v29
    v_fma_f32 v97, v97, v31, v29
    v_fma_f32 v98, v98, v31, v29
    v_fma_f32 v99, v99, v31, v29
    v_fma_f32 v100, v100, v31, v29
    v_fma_f32 v101, v101, v31, v29
    v_fma_f32 v102, v102, v31, v29
    v_fma_f32 v103, v103, v31, v29
    v_mul_f32 v96, v96, v56
    v_mul_f32 v97, v97, v57
    v_mul_f32 v98, v98, v58
    v_mul_f32 v99, v99, v59
    v_mul_f32 v100, v100, v60
    v_mul_f32 v101, v101, v61
    v_mul_f32 v102, v102, v62
    v_mul_f32 v103, v103, v63
    v_exp_f32 v96, v96
    v_exp_f32 v97, v97
    v_exp_f32 v98, v98
    v_exp_f32 v99, v99
    v_exp_f32 v100, v100
    v_exp_f32 v101, v101
    v_exp_f32 v102, v102
    v_exp_f32 v103, v103
    v_fma_f32 v96, v96, v15, v15
    v_fma_f32 v97, v97, v15, v15
    v_fma_f32 v98, v98, v15, v15
    v_fma_f32 v99, v99, v15, v15
    v_fma_f32 v100, v100, v15, v15
    v_fma_f32 v101, v101, v15, v15
    v_fma_f32 v102, v102, v15, v15
    v_fma_f32 v103, v103, v15, v15
    v_rcp_f32 v96, v96
    v_rcp_f32 v97, v97
    v_rcp_f32 v98, v98
    v_rcp_f32 v99, v99
    v_rcp_f32 v100, v100
    v_rcp_f32 v101, v101
    v_rcp_f32 v102, v102
    v_rcp_f32 v103, v103
    v_mul_f32 v96, v96, v56
    v_mul_f32 v97, v97, v57
    v_mul_f32 v98, v98, v58
    v_mul_f32 v99, v99, v59
    v_mul_f32 v100, v100, v60
    v_mul_f32 v101, v101, v61
    v_mul_f32 v102, v102, v62
    v_mul_f32 v103, v103, v63
    v_cvt_pk_bf16_f32 v116, v96, v97
    v_cvt_pk_bf16_f32 v117, v98, v99
    v_cvt_pk_bf16_f32 v118, v100, v101
    v_cvt_pk_bf16_f32 v119, v102, v103
    buffer_store_dwordx4 v[116:119], v25, s[48:51], s77 offen offset:1024 sc1
    s_waitcnt vmcnt(2)
    v_mov_b32 v27, 1
    s_mov_b64 exec, 1
    buffer_store_dword v27, v26, s[64:67], 0 offen sc1
    s_mov_b64 exec, -1
    v_mul_f32 v96, v64, v64
    v_mul_f32 v97, v65, v65
    v_mul_f32 v98, v66, v66
    v_mul_f32 v99, v67, v67
    v_mul_f32 v100, v68, v68
    v_mul_f32 v101, v69, v69
    v_mul_f32 v102, v70, v70
    v_mul_f32 v103, v71, v71
    v_fma_f32 v96, v96, v30, v28
    v_fma_f32 v97, v97, v30, v28
    v_fma_f32 v98, v98, v30, v28
    v_fma_f32 v99, v99, v30, v28
    v_fma_f32 v100, v100, v30, v28
    v_fma_f32 v101, v101, v30, v28
    v_fma_f32 v102, v102, v30, v28
    v_fma_f32 v103, v103, v30, v28
    v_mul_f32 v96, v96, v64
    v_mul_f32 v97, v97, v65
    v_mul_f32 v98, v98, v66
    v_mul_f32 v99, v99, v67
    v_mul_f32 v100, v100, v68
    v_mul_f32 v101, v101, v69
    v_mul_f32 v102, v102, v70
    v_mul_f32 v103, v103, v71
    v_exp_f32 v96, v96
    v_exp_f32 v97, v97
    v_exp_f32 v98, v98
    v_exp_f32 v99, v99
    v_exp_f32 v100, v100
    v_exp_f32 v101, v101
    v_exp_f32 v102, v102
    v_exp_f32 v103, v103
    v_fma_f32 v96, v96, v13, v13
    v_fma_f32 v97, v97, v13, v13
    v_fma_f32 v98, v98, v13, v13
    v_fma_f32 v99, v99, v13, v13
    v_fma_f32 v100, v100, v13, v13
    v_fma_f32 v101, v101, v13, v13
    v_fma_f32 v102, v102, v13, v13
    v_fma_f32 v103, v103, v13, v13
    v_rcp_f32 v96, v96
    v_rcp_f32 v97, v97
    v_rcp_f32 v98, v98
    v_rcp_f32 v99, v99
    v_rcp_f32 v100, v100
    v_rcp_f32 v101, v101
    v_rcp_f32 v102, v102
    v_rcp_f32 v103, v103
    v_mul_f32 v96, v96, v64
    v_mul_f32 v97, v97, v65
    v_mul_f32 v98, v98, v66
    v_mul_f32 v99, v99, v67
    v_mul_f32 v100, v100, v68
    v_mul_f32 v101, v101, v69
    v_mul_f32 v102, v102, v70
    v_mul_f32 v103, v103, v71
    v_cvt_pk_bf16_f32 v104, v96, v97
    v_cvt_pk_bf16_f32 v105, v98, v99
    v_cvt_pk_bf16_f32 v106, v100, v101
    v_cvt_pk_bf16_f32 v107, v102, v103
    buffer_store_dwordx4 v[104:107], v24, s[48:51], s78 offen offset:0 sc1
    v_mul_f32 v96, v80, v80
    v_mul_f32 v97, v81, v81
    v_mul_f32 v98, v82, v82
    v_mul_f32 v99, v83, v83
    v_mul_f32 v100, v84, v84
    v_mul_f32 v101, v85, v85
    v_mul_f32 v102, v86, v86
    v_mul_f32 v103, v87, v87
    v_fma_f32 v96, v96, v31, v29
    v_fma_f32 v97, v97, v31, v29
    v_fma_f32 v98, v98, v31, v29
    v_fma_f32 v99, v99, v31, v29
    v_fma_f32 v100, v100, v31, v29
    v_fma_f32 v101, v101, v31, v29
    v_fma_f32 v102, v102, v31, v29
    v_fma_f32 v103, v103, v31, v29
    v_mul_f32 v96, v96, v80
    v_mul_f32 v97, v97, v81
    v_mul_f32 v98, v98, v82
    v_mul_f32 v99, v99, v83
    v_mul_f32 v100, v100, v84
    v_mul_f32 v101, v101, v85
    v_mul_f32 v102, v102, v86
    v_mul_f32 v103, v103, v87
    v_exp_f32 v96, v96
    v_exp_f32 v97, v97
    v_exp_f32 v98, v98
    v_exp_f32 v99, v99
    v_exp_f32 v100, v100
    v_exp_f32 v101, v101
    v_exp_f32 v102, v102
    v_exp_f32 v103, v103
    v_fma_f32 v96, v96, v15, v15
    v_fma_f32 v97, v97, v15, v15
    v_fma_f32 v98, v98, v15, v15
    v_fma_f32 v99, v99, v15, v15
    v_fma_f32 v100, v100, v15, v15
    v_fma_f32 v101, v101, v15, v15
    v_fma_f32 v102, v102, v15, v15
    v_fma_f32 v103, v103, v15, v15
    v_rcp_f32 v96, v96
    v_rcp_f32 v97, v97
    v_rcp_f32 v98, v98
    v_rcp_f32 v99, v99
    v_rcp_f32 v100, v100
    v_rcp_f32 v101, v101
    v_rcp_f32 v102, v102
    v_rcp_f32 v103, v103
    v_mul_f32 v96, v96, v80
    v_mul_f32 v97, v97, v81
    v_mul_f32 v98, v98, v82
    v_mul_f32 v99, v99, v83
    v_mul_f32 v100, v100, v84
    v_mul_f32 v101, v101, v85
    v_mul_f32 v102, v102, v86
    v_mul_f32 v103, v103, v87
    v_cvt_pk_bf16_f32 v108, v96, v97
    v_cvt_pk_bf16_f32 v109, v98, v99
    v_cvt_pk_bf16_f32 v110, v100, v101
    v_cvt_pk_bf16_f32 v111, v102, v103
    buffer_store_dwordx4 v[108:111], v25, s[48:51], s78 offen offset:0 sc1
    s_waitcnt vmcnt(3)
    v_mov_b32 v27, 2
    s_mov_b64 exec, 1
    buffer_store_dword v27, v26, s[64:67], 0 offen sc1
    s_mov_b64 exec, -1
    v_mul_f32 v96, v72, v72
    v_mul_f32 v97, v73, v73
    v_mul_f32 v98, v74, v74
    v_mul_f32 v99, v75, v75
    v_mul_f32 v100, v76, v76
    v_mul_f32 v101, v77, v77
    v_mul_f32 v102, v78, v78
    v_mul_f32 v103, v79, v79
    v_fma_f32 v96, v96, v30, v28
    v_fma_f32 v97, v97, v30, v28
    v_fma_f32 v98, v98, v30, v28
    v_fma_f32 v99, v99, v30, v28
    v_fma_f32 v100, v100, v30, v28
    v_fma_f32 v101, v101, v30, v28
    v_fma_f32 v102, v102, v30, v28
    v_fma_f32 v103, v103, v30, v28
    v_mul_f32 v96, v96, v72
    v_mul_f32 v97, v97, v73
    v_mul_f32 v98, v98, v74
    v_mul_f32 v99, v99, v75
    v_mul_f32 v100, v100, v76
    v_mul_f32 v101, v101, v77
    v_mul_f32 v102, v102, v78
    v_mul_f32 v103, v103, v79
    v_exp_f32 v96, v96
    v_exp_f32 v97, v97
    v_exp_f32 v98, v98
    v_exp_f32 v99, v99
    v_exp_f32 v100, v100
    v_exp_f32 v101, v101
    v_exp_f32 v102, v102
    v_exp_f32 v103, v103
    v_fma_f32 v96, v96, v13, v13
    v_fma_f32 v97, v97, v13, v13
    v_fma_f32 v98, v98, v13, v13
    v_fma_f32 v99, v99, v13, v13
    v_fma_f32 v100, v100, v13, v13
    v_fma_f32 v101, v101, v13, v13
    v_fma_f32 v102, v102, v13, v13
    v_fma_f32 v103, v103, v13, v13
    v_rcp_f32 v96, v96
    v_rcp_f32 v97, v97
    v_rcp_f32 v98, v98
    v_rcp_f32 v99, v99
    v_rcp_f32 v100, v100
    v_rcp_f32 v101, v101
    v_rcp_f32 v102, v102
    v_rcp_f32 v103, v103
    v_mul_f32 v96, v96, v72
    v_mul_f32 v97, v97, v73
    v_mul_f32 v98, v98, v74
    v_mul_f32 v99, v99, v75
    v_mul_f32 v100, v100, v76
    v_mul_f32 v101, v101, v77
    v_mul_f32 v102, v102, v78
    v_mul_f32 v103, v103, v79
    v_cvt_pk_bf16_f32 v112, v96, v97
    v_cvt_pk_bf16_f32 v113, v98, v99
    v_cvt_pk_bf16_f32 v114, v100, v101
    v_cvt_pk_bf16_f32 v115, v102, v103
    buffer_store_dwordx4 v[112:115], v24, s[48:51], s78 offen offset:1024 sc1
    s_load_dwordx2 s[6:7], s[32:33], 0 glc
    s_load_dwordx2 s[8:9], s[32:33], 64 glc
    s_load_dwordx2 s[10:11], s[32:33], 128 glc
    s_load_dwordx2 s[12:13], s[32:33], 192 glc
    v_mul_f32 v96, v88, v88
    v_mul_f32 v97, v89, v89
    v_mul_f32 v98, v90, v90
    v_mul_f32 v99, v91, v91
    v_mul_f32 v100, v92, v92
    v_mul_f32 v101, v93, v93
    v_mul_f32 v102, v94, v94
    v_mul_f32 v103, v95, v95
    v_fma_f32 v96, v96, v31, v29
    v_fma_f32 v97, v97, v31, v29
    v_fma_f32 v98, v98, v31, v29
    v_fma_f32 v99, v99, v31, v29
    v_fma_f32 v100, v100, v31, v29
    v_fma_f32 v101, v101, v31, v29
    v_fma_f32 v102, v102, v31, v29
    v_fma_f32 v103, v103, v31, v29
    v_mul_f32 v96, v96, v88
    v_mul_f32 v97, v97, v89
    v_mul_f32 v98, v98, v90
    v_mul_f32 v99, v99, v91
    v_mul_f32 v100, v100, v92
    v_mul_f32 v101, v101, v93
    v_mul_f32 v102, v102, v94
    v_mul_f32 v103, v103, v95
    v_exp_f32 v96, v96
    v_exp_f32 v97, v97
    v_exp_f32 v98, v98
    v_exp_f32 v99, v99
    v_exp_f32 v100, v100
    v_exp_f32 v101, v101
    v_exp_f32 v102, v102
    v_exp_f32 v103, v103
    v_fma_f32 v96, v96, v15, v15
    v_fma_f32 v97, v97, v15, v15
    v_fma_f32 v98, v98, v15, v15
    v_fma_f32 v99, v99, v15, v15
    v_fma_f32 v100, v100, v15, v15
    v_fma_f32 v101, v101, v15, v15
    v_fma_f32 v102, v102, v15, v15
    v_fma_f32 v103, v103, v15, v15
    v_rcp_f32 v96, v96
    v_rcp_f32 v97, v97
    v_rcp_f32 v98, v98
    v_rcp_f32 v99, v99
    v_rcp_f32 v100, v100
    v_rcp_f32 v101, v101
    v_rcp_f32 v102, v102
    v_rcp_f32 v103, v103
    v_mul_f32 v96, v96, v88
    v_mul_f32 v97, v97, v89
    v_mul_f32 v98, v98, v90
    v_mul_f32 v99, v99, v91
    v_mul_f32 v100, v100, v92
    v_mul_f32 v101, v101, v93
    v_mul_f32 v102, v102, v94
    v_mul_f32 v103, v103, v95
    v_cvt_pk_bf16_f32 v116, v96, v97
    v_cvt_pk_bf16_f32 v117, v98, v99
    v_cvt_pk_bf16_f32 v118, v100, v101
    v_cvt_pk_bf16_f32 v119, v102, v103
    buffer_store_dwordx4 v[116:119], v25, s[48:51], s78 offen offset:1024 sc1
    s_waitcnt vmcnt(3)
    v_mov_b32 v27, 3
    s_mov_b64 exec, 1
    buffer_store_dword v27, v26, s[64:67], 0 offen sc1
    s_mov_b64 exec, -1
    s_add_u32 m0, s81, 32768
    s_lshl4_add_u32 s89, s93, s98
    buffer_load_dwordx4 v128, s[24:27], s89 offen lds
    buffer_load_dwordx4 v129, s[24:27], s89 offen offset:1024 lds
    s_add_u32 m0, s81, 34816
    s_lshl4_add_u32 s89, s94, s98
    buffer_load_dwordx4 v128, s[24:27], s89 offen lds
    buffer_load_dwordx4 v129, s[24:27], s89 offen offset:1024 lds
    s_add_u32 m0, s80, 49152
    s_lshl4_add_u32 s89, s95, s98
    buffer_load_dwordx4 v128, s[24:27], s89 offen lds
    buffer_load_dwordx4 v129, s[24:27], s89 offen offset:1024 lds
    s_add_u32 m0, s81, 0
    s_lshl4_add_u32 s89, s96, s98
    buffer_load_dwordx4 v128, s[24:27], s89 offen lds
    buffer_load_dwordx4 v129, s[24:27], s89 offen offset:1024 lds
    s_add_u32 m0, s81, 2048
    s_lshl4_add_u32 s89, s90, s99
    buffer_load_dwordx4 v128, s[24:27], s89 offen lds
    buffer_load_dwordx4 v129, s[24:27], s89 offen offset:1024 lds
    s_add_u32 m0, s80, 57344
    s_lshl4_add_u32 s89, s91, s99
    buffer_load_dwordx4 v128, s[24:27], s89 offen lds
    buffer_load_dwordx4 v129, s[24:27], s89 offen offset:1024 lds
    s_add_u32 m0, s80, 65536
    s_lshl4_add_u32 s89, s92, s99
    buffer_load_dwordx4 v128, s[24:27], s89 offen lds
    buffer_load_dwordx4 v129, s[24:27], s89 offen offset:1024 lds
    s_add_u32 m0, s81, 16384
    s_lshl4_add_u32 s89, s93, s99
    buffer_load_dwordx4 v128, s[24:27], s89 offen lds
    buffer_load_dwordx4 v129, s[24:27], s89 offen offset:1024 lds
    s_add_u32 m0, s81, 18432
    s_lshl4_add_u32 s89, s94, s99
    buffer_load_dwordx4 v128, s[24:27], s89 offen lds
    buffer_load_dwordx4 v129, s[24:27], s89 offen offset:1024 lds
    s_add_u32 m0, s80, 73728
    s_lshl4_add_u32 s89, s95, s99
    buffer_load_dwordx4 v128, s[24:27], s89 offen lds
    buffer_load_dwordx4 v129, s[24:27], s89 offen offset:1024 lds
    s_waitcnt vmcnt(21)
    v_mov_b32 v27, 4
    s_mov_b64 exec, 1
    buffer_store_dword v27, v26, s[64:67], 0 offen sc1
    s_mov_b64 exec, -1
    s_waitcnt lgkmcnt(0)
    s_min_u32 s42, s6, s7
    s_min_u32 s42, s42, s8
    s_min_u32 s42, s42, s9
    s_min_u32 s42, s42, s10
    s_min_u32 s42, s42, s11
    s_min_u32 s42, s42, s12
    s_min_u32 s42, s42, s13
    s_max_u32 s101, s101, s42
    s_cmp_ge_u32 s101, 1
    s_cbranch_scc0 L_g1_h0_slow
L_g1_h0_back:
    s_load_dwordx2 s[14:15], s[32:33], 0 glc
    s_load_dwordx2 s[16:17], s[32:33], 64 glc
    s_load_dwordx2 s[18:19], s[32:33], 128 glc
    s_load_dwordx2 s[20:21], s[32:33], 192 glc
    buffer_load_dwordx4 v[220:223], v132, s[60:63], s90 offen offset:0 sc1
    buffer_load_dwordx4 v[224:227], v133, s[60:63], s90 offen offset:0 sc1
    buffer_load_dwordx4 v[228:231], v132, s[60:63], s91 offen offset:0 sc1
    buffer_load_dwordx4 v[232:235], v133, s[60:63], s91 offen offset:0 sc1
    buffer_load_dwordx4 v[96:99], v132, s[60:63], s92 offen offset:0 sc1
    buffer_load_dwordx4 v[100:103], v133, s[60:63], s92 offen offset:0 sc1
    buffer_load_dwordx4 v[120:123], v132, s[60:63], s93 offen offset:0 sc1
    buffer_load_dwordx4 v[124:127], v133, s[60:63], s93 offen offset:0 sc1
    buffer_load_dwordx4 v[104:107], v132, s[60:63], s94 offen offset:0 sc1
    buffer_load_dwordx4 v[108:111], v133, s[60:63], s94 offen offset:0 sc1
    s_branch L_g2
L_service:
    s_cmp_eq_u32 s74, 28
    s_cbranch_scc0 L_sv_done
    s_cmp_eq_u32 s40, 3
    s_cbranch_scc0 L_sv_done
    s_getpc_b64 s[44:45]
L_pf_pc:
    s_sub_u32 s44, s44, L_pf_pc-CODE_BEGIN
    s_subb_u32 s45, s45, 0
    v_lshlrev_b32 v37, 4, v1
    v_min_u32 v36, CODE_END-CODE_BEGIN-16, v37
    global_load_dwordx4 v[244:247], v36, s[44:45]
    v_add_u32 v37, 1024, v37
    v_min_u32 v36, CODE_END-CODE_BEGIN-16, v37
    global_load_dwordx4 v[244:247], v36, s[44:45]
    v_add_u32 v37, 1024, v37
    v_min_u32 v36, CODE_END-CODE_BEGIN-16, v37
    global_load_dwordx4 v[244:247], v36, s[44:45]
    v_add_u32 v37, 1024, v37
    v_min_u32 v36, CODE_END-CODE_BEGIN-16, v37
    global_load_dwordx4 v[244:247], v36, s[44:45]
    v_add_u32 v37, 1024, v37
    v_min_u32 v36, CODE_END-CODE_BEGIN-16, v37
    global_load_dwordx4 v[244:247], v36, s[44:45]
    v_add_u32 v37, 1024, v37
    v_min_u32 v36, CODE_END-CODE_BEGIN-16, v37
    global_load_dwordx4 v[244:247], v36, s[44:45]
    v_add_u32 v37, 1024, v37
    v_min_u32 v36, CODE_END-CODE_BEGIN-16, v37
    global_load_dwordx4 v[244:247], v36, s[44:45]
    v_add_u32 v37, 1024, v37
    v_min_u32 v36, CODE_END-CODE_BEGIN-16, v37
    global_load_dwordx4 v[244:247], v36, s[44:45]
    v_add_u32 v37, 1024, v37
    v_min_u32 v36, CODE_END-CODE_BEGIN-16, v37
    global_load_dwordx4 v[244:247], v36, s[44:45]
    v_add_u32 v37, 1024, v37
    v_min_u32 v36, CODE_END-CODE_BEGIN-16, v37
    global_load_dwordx4 v[244:247], v36, s[44:45]
    v_add_u32 v37, 1024, v37
    v_min_u32 v36, CODE_END-CODE_BEGIN-16, v37
    global_load_dwordx4 v[244:247], v36, s[44:45]
    v_add_u32 v37, 1024, v37
    v_min_u32 v36, CODE_END-CODE_BEGIN-16, v37
    global_load_dwordx4 v[244:247], v36, s[44:45]
    v_add_u32 v37, 1024, v37
    v_min_u32 v36, CODE_END-CODE_BEGIN-16, v37
    global_load_dwordx4 v[244:247], v36, s[44:45]
    v_add_u32 v37, 1024, v37
    v_min_u32 v36, CODE_END-CODE_BEGIN-16, v37
    global_load_dwordx4 v[244:247], v36, s[44:45]
    v_add_u32 v37, 1024, v37
    v_min_u32 v36, CODE_END-CODE_BEGIN-16, v37
    global_load_dwordx4 v[244:247], v36, s[44:45]
    v_add_u32 v37, 1024, v37
    v_min_u32 v36, CODE_END-CODE_BEGIN-16, v37
    global_load_dwordx4 v[244:247], v36, s[44:45]
    v_add_u32 v37, 1024, v37
    v_min_u32 v36, CODE_END-CODE_BEGIN-16, v37
    global_load_dwordx4 v[244:247], v36, s[44:45]
    v_add_u32 v37, 1024, v37
    v_min_u32 v36, CODE_END-CODE_BEGIN-16, v37
    global_load_dwordx4 v[244:247], v36, s[44:45]
    v_add_u32 v37, 1024, v37
    v_min_u32 v36, CODE_END-CODE_BEGIN-16, v37
    global_load_dwordx4 v[244:247], v36, s[44:45]
    v_add_u32 v37, 1024, v37
    v_min_u32 v36, CODE_END-CODE_BEGIN-16, v37
    global_load_dwordx4 v[244:247], v36, s[44:45]
    v_add_u32 v37, 1024, v37
    v_min_u32 v36, CODE_END-CODE_BEGIN-16, v37
    global_load_dwordx4 v[244:247], v36, s[44:45]
    v_add_u32 v37, 1024, v37
    v_min_u32 v36, CODE_END-CODE_BEGIN-16, v37
    global_load_dwordx4 v[244:247], v36, s[44:45]
    v_add_u32 v37, 1024, v37
    v_min_u32 v36, CODE_END-CODE_BEGIN-16, v37
    global_load_dwordx4 v[244:247], v36, s[44:45]
    v_add_u32 v37, 1024, v37
    v_min_u32 v36, CODE_END-CODE_BEGIN-16, v37
    global_load_dwordx4 v[244:247], v36, s[44:45]
    v_add_u32 v37, 1024, v37
    v_min_u32 v36, CODE_END-CODE_BEGIN-16, v37
    global_load_dwordx4 v[244:247], v36, s[44:45]
    v_add_u32 v37, 1024, v37
    v_min_u32 v36, CODE_END-CODE_BEGIN-16, v37
    global_load_dwordx4 v[244:247], v36, s[44:45]
    v_add_u32 v37, 1024, v37
    v_min_u32 v36, CODE_END-CODE_BEGIN-16, v37
    global_load_dwordx4 v[244:247], v36, s[44:45]
    v_add_u32 v37, 1024, v37
    v_min_u32 v36, CODE_END-CODE_BEGIN-16, v37
    global_load_dwordx4 v[244:247], v36, s[44:45]
    v_add_u32 v37, 1024, v37
    v_min_u32 v36, CODE_END-CODE_BEGIN-16, v37
    global_load_dwordx4 v[244:247], v36, s[44:45]
    v_add_u32 v37, 1024, v37
    v_min_u32 v36, CODE_END-CODE_BEGIN-16, v37
    global_load_dwordx4 v[244:247], v36, s[44:45]
    v_add_u32 v37, 1024, v37
    v_min_u32 v36, CODE_END-CODE_BEGIN-16, v37
    global_load_dwordx4 v[244:247], v36, s[44:45]
    v_add_u32 v37, 1024, v37
    v_min_u32 v36, CODE_END-CODE_BEGIN-16, v37
    global_load_dwordx4 v[244:247], v36, s[44:45]
    v_add_u32 v37, 1024, v37
    v_min_u32 v36, CODE_END-CODE_BEGIN-16, v37
    global_load_dwordx4 v[244:247], v36, s[44:45]
    v_add_u32 v37, 1024, v37
    v_min_u32 v36, CODE_END-CODE_BEGIN-16, v37
    global_load_dwordx4 v[244:247], v36, s[44:45]
    v_add_u32 v37, 1024, v37
    v_min_u32 v36, CODE_END-CODE_BEGIN-16, v37
    global_load_dwordx4 v[244:247], v36, s[44:45]
    v_add_u32 v37, 1024, v37
    v_min_u32 v36, CODE_END-CODE_BEGIN-16, v37
    global_load_dwordx4 v[244:247], v36, s[44:45]
    v_add_u32 v37, 1024, v37
    v_min_u32 v36, CODE_END-CODE_BEGIN-16, v37
    global_load_dwordx4 v[244:247], v36, s[44:45]
    v_add_u32 v37, 1024, v37
    v_min_u32 v36, CODE_END-CODE_BEGIN-16, v37
    global_load_dwordx4 v[244:247], v36, s[44:45]
    v_add_u32 v37, 1024, v37
L_sv_done:
    s_waitcnt lgkmcnt(0)
    s_add_u32 s64, s38, 0xb10000
    s_addc_u32 s65, s39, 0
    s_mov_b32 s66, 0x8000
    s_mov_b32 s67, 0x20000
    s_mov_b32 s68, s36
    s_mov_b32 s69, s37
    s_mov_b32 s70, 0x100
    s_mov_b32 s71, 0x20000
    s_cmp_eq_u32 s40, 0
    s_cbranch_scc0 L_sv_rdyw_skip
    v_mov_b32 v33, 0
    s_mov_b32 s45, 200000
L_sv_rdy_spin:
    s_mov_b64 exec, 0x1
    buffer_load_dword v34, v33, s[68:71], 0 offen offset:0 sc1
    s_waitcnt vmcnt(0)
    v_cmp_eq_u32 vcc, 1, v34
    s_mov_b64 s[46:47], exec
    s_mov_b64 exec, -1
    s_nop 1
    s_cmp_eq_u64 vcc, s[46:47]
    s_cbranch_scc1 L_sv_rdy_done
    s_sleep 12
    s_sub_u32 s45, s45, 1
    s_cmp_lg_u32 s45, 0
    s_cbranch_scc1 L_sv_rdy_spin
L_sv_rdy_done:
L_sv_rdyw_skip:
    s_barrier
    s_lshl_b32 s42, s41, 5
    s_add_u32 s42, s42, 0
    v_mov_b32 v33, s42
    s_mov_b32 s45, 200000
L_sv_p0_spin:
    s_mov_b64 exec, 0x1
    buffer_load_dword v34, v33, s[64:67], 0 offen offset:0 sc1
    s_waitcnt vmcnt(0)
    v_cmp_eq_u32 vcc, 1, v34
    s_mov_b64 s[46:47], exec
    s_mov_b64 exec, -1
    s_nop 1
    s_cmp_eq_u64 vcc, s[46:47]
    s_cbranch_scc1 L_sv_p0_done
    s_sleep 2
    s_sub_u32 s45, s45, 1
    s_cmp_lg_u32 s45, 0
    s_cbranch_scc1 L_sv_p0_spin
L_sv_p0_done:
    s_mov_b32 s52, s28
    s_mov_b32 s53, s29
    s_mov_b32 s54, 0x1c0000
    s_mov_b32 s55, 0x20000
    s_sub_u32 s42, s74, 28
    s_lshl_b32 s42, s42, 2
    s_add_u32 s42, s42, s40
    s_mul_i32 s42, s42, 114688
    v_lshrrev_b32 v2, 2, v1
    v_lshlrev_b32 v2, 10, v2
    v_and_b32 v3, 3, v1
    v_lshl_add_u32 v2, v3, 7, v2
    s_and_b32 s43, s75, 1
    s_lshl_b32 s43, s43, 9
    v_add_u32 v2, s43, v2
    s_mov_b32 s43, 7
L_w2pf:
    buffer_load_dword v40, v2, s[52:55], s42 offen
    s_add_u32 s42, s42, 16384
    s_waitcnt vmcnt(6)
    s_sub_u32 s43, s43, 1
    s_cmp_lg_u32 s43, 0
    s_cbranch_scc1 L_w2pf
    s_lshr_b32 s42, s75, 1
    s_lshl_b32 s42, s42, 3
    s_lshr_b32 s44, s74, 2
    s_add_u32 s87, s42, s44
    s_and_b32 s42, s75, 1
    s_lshl_b32 s42, s42, 2
    s_and_b32 s43, s74, 3
    s_add_u32 s88, s42, s43
    s_and_b32 s76, s87, 1
    s_lshl_b32 s42, s43, 1
    s_add_u32 s42, s42, s44
    s_cmp_ge_u32 s42, 7
    s_cselect_b32 s43, 7, 0
    s_sub_u32 s42, s42, s43
    s_mul_i32 s44, s40, 28672
    s_lshl_b32 s43, s42, 12
    s_add_u32 s90, s43, s44
    s_add_u32 s42, s42, 1
    s_cmp_eq_u32 s42, 7
    s_cselect_b32 s42, 0, s42
    s_lshl_b32 s43, s42, 12
    s_add_u32 s91, s43, s44
    s_add_u32 s42, s42, 1
    s_cmp_eq_u32 s42, 7
    s_cselect_b32 s42, 0, s42
    s_lshl_b32 s43, s42, 12
    s_add_u32 s92, s43, s44
    s_add_u32 s42, s42, 1
    s_cmp_eq_u32 s42, 7
    s_cselect_b32 s42, 0, s42
    s_lshl_b32 s43, s42, 12
    s_add_u32 s93, s43, s44
    s_add_u32 s42, s42, 1
    s_cmp_eq_u32 s42, 7
    s_cselect_b32 s42, 0, s42
    s_lshl_b32 s43, s42, 12
    s_add_u32 s94, s43, s44
    s_add_u32 s42, s42, 1
    s_cmp_eq_u32 s42, 7
    s_cselect_b32 s42, 0, s42
    s_lshl_b32 s43, s42, 12
    s_add_u32 s95, s43, s44
    s_add_u32 s42, s42, 1
    s_cmp_eq_u32 s42, 7
    s_cselect_b32 s42, 0, s42
    s_lshl_b32 s43, s42, 12
    s_add_u32 s96, s43, s44
    s_lshl_b32 s97, s76, 15
    s_add_u32 s98, s97, 16384
    s_sub_u32 s99, 32768, s97
    s_add_u32 s100, s99, 16384
    s_lshl_b32 s42, s88, 7
    s_sub_u32 s43, 1835008, s42
    s_add_u32 s24, s28, s42
    s_addc_u32 s25, s29, 0
    s_mov_b32 s26, s43
    s_mov_b32 s27, 0x20000
    s_mul_i32 s42, s87, 229376
    s_add_u32 s42, s42, 0x400000
    s_add_u32 s60, s38, s42
    s_addc_u32 s61, s39, 0
    s_mov_b32 s62, 0x38000
    s_mov_b32 s63, 0x20000
    s_and_b32 s82, s40, 1
    s_lshr_b32 s83, s40, 1
    v_lshrrev_b32 v96, 3, v1
    v_and_b32 v97, 7, v1
    v_lshrrev_b32 v98, 2, v97
    v_lshrrev_b32 v99, 1, v96
    v_and_b32 v99, 1, v99
    v_xor_b32 v98, v98, v99
    v_and_b32 v97, 3, v97
    v_lshl_add_u32 v98, v98, 2, v97
    v_lshlrev_b32 v96, 10, v96
    v_lshl_add_u32 v128, v98, 4, v96
    v_add_u32 v129, 7168, v128
    s_lshl_b32 s81, s40, 12
    s_lshl_b32 s80, s40, 11
    v_lshrrev_b32 v96, 4, v1
    v_and_b32 v97, 15, v1
    v_lshrrev_b32 v98, 2, v97
    v_and_b32 v97, 3, v97
    v_lshrrev_b32 v99, 1, v96
    v_and_b32 v96, 1, v96
    v_lshl_add_u32 v99, v99, 2, v98
    v_lshlrev_b32 v99, 7, v99
    v_lshl_add_u32 v99, v96, 5, v99
    v_lshl_add_u32 v99, v97, 3, v99
    v_lshrrev_b32 v98, 1, v98
    v_xor_b32 v98, s82, v98
    v_lshl_add_u32 v130, v98, 6, v99
    v_xor_b32 v98, 1, v98
    v_lshl_add_u32 v131, v98, 6, v99
    s_add_u32 s42, s80, 49152
    v_add_u32 v218, s42, v130
    v_add_u32 v130, s81, v130
    v_add_u32 v219, s42, v131
    v_add_u32 v131, s81, v131
    v_lshlrev_b32 v98, 4, v1
    s_lshl_b32 s43, s76, 11
    v_add_u32 v98, s43, v98
    s_mul_i32 s42, s83, 114688
    v_add_u32 v132, s42, v98
    s_sub_u32 s42, 114688, s42
    v_add_u32 v133, s42, v98
    s_lshl_b32 s43, s43, 1
    s_sub_u32 s43, 2048, s43
    v_add_u32 v134, s43, v132
    v_add_u32 v135, s43, v133
    s_lshr_b32 s42, s87, 1
    s_mul_i32 s42, s42, 14
    s_mul_i32 s43, s40, 7
    s_lshr_b32 s43, s43, 1
    s_add_u32 s42, s42, s43
    s_lshl_b32 s42, s42, 6
    s_lshl_b32 s43, s76, 3
    s_add_u32 s42, s42, s43
    s_add_u32 s42, s42, 0xb14000
    s_add_u32 s32, s38, s42
    s_addc_u32 s33, s39, 0
    s_lshl_b32 s42, s88, 5
    v_add_u32 v137, s42, v1
    v_lshlrev_b32 v137, 5, v137
    v_add_u32 v137, 8192, v137
    s_lshr_b32 s42, s87, 2
    s_and_b32 s43, s87, 3
    s_lshl_b32 s43, s43, 6
    s_add_u32 s42, s42, s43
    v_subrev_u32 v96, 32, v1
    v_lshlrev_b32 v96, 3, v96
    v_add_u32 v96, s42, v96
    v_lshlrev_b32 v96, 5, v96
    v_add_u32 v96, 0, v96
    v_cmp_gt_u32 vcc, 32, v1
    s_nop 1
    v_cndmask_b32 v137, v96, v137, vcc
    s_mov_b32 s101, 0
    s_add_u32 m0, s81, 32768
    s_lshl4_add_u32 s89, s90, s97
    buffer_load_dwordx4 v128, s[24:27], s89 offen lds
    buffer_load_dwordx4 v129, s[24:27], s89 offen offset:1024 lds
    s_add_u32 m0, s81, 34816
    s_lshl4_add_u32 s89, s91, s97
    buffer_load_dwordx4 v128, s[24:27], s89 offen lds
    buffer_load_dwordx4 v129, s[24:27], s89 offen offset:1024 lds
    s_add_u32 m0, s80, 49152
    s_lshl4_add_u32 s89, s92, s97
    buffer_load_dwordx4 v128, s[24:27], s89 offen lds
    buffer_load_dwordx4 v129, s[24:27], s89 offen offset:1024 lds
    s_add_u32 m0, s81, 0
    s_lshl4_add_u32 s89, s93, s97
    buffer_load_dwordx4 v128, s[24:27], s89 offen lds
    buffer_load_dwordx4 v129, s[24:27], s89 offen offset:1024 lds
    s_add_u32 m0, s81, 2048
    s_lshl4_add_u32 s89, s94, s97
    buffer_load_dwordx4 v128, s[24:27], s89 offen lds
    buffer_load_dwordx4 v129, s[24:27], s89 offen offset:1024 lds
    s_add_u32 m0, s80, 57344
    s_lshl4_add_u32 s89, s95, s97
    buffer_load_dwordx4 v128, s[24:27], s89 offen lds
    buffer_load_dwordx4 v129, s[24:27], s89 offen offset:1024 lds
    s_add_u32 m0, s80, 65536
    s_lshl4_add_u32 s89, s96, s97
    buffer_load_dwordx4 v128, s[24:27], s89 offen lds
    buffer_load_dwordx4 v129, s[24:27], s89 offen offset:1024 lds
    s_add_u32 m0, s81, 16384
    s_lshl4_add_u32 s89, s90, s98
    buffer_load_dwordx4 v128, s[24:27], s89 offen lds
    buffer_load_dwordx4 v129, s[24:27], s89 offen offset:1024 lds
    s_add_u32 m0, s81, 18432
    s_lshl4_add_u32 s89, s91, s98
    buffer_load_dwordx4 v128, s[24:27], s89 offen lds
    buffer_load_dwordx4 v129, s[24:27], s89 offen offset:1024 lds
    s_add_u32 m0, s80, 73728
    s_lshl4_add_u32 s89, s92, s98
    buffer_load_dwordx4 v128, s[24:27], s89 offen lds
    buffer_load_dwordx4 v129, s[24:27], s89 offen offset:1024 lds
    s_mov_b32 s48, s38
    s_mov_b32 s49, s39
    s_mov_b32 s50, 0x1000000
    s_mov_b32 s51, 0x20000
    s_waitcnt vmcnt(0)
    ds_read_b64_tr_b16 v[138:139], v130 offset:32768
    ds_read_b64_tr_b16 v[140:141], v130 offset:33792
    ds_read_b64_tr_b16 v[142:143], v131 offset:32768
    ds_read_b64_tr_b16 v[144:145], v131 offset:33792
    ds_read_b64_tr_b16 v[146:147], v130 offset:34816
    ds_read_b64_tr_b16 v[148:149], v130 offset:35840
    ds_read_b64_tr_b16 v[150:151], v131 offset:34816
    ds_read_b64_tr_b16 v[152:153], v131 offset:35840
    ds_read_b64_tr_b16 v[154:155], v218 offset:0
    ds_read_b64_tr_b16 v[156:157], v218 offset:1024
    ds_read_b64_tr_b16 v[158:159], v219 offset:0
    ds_read_b64_tr_b16 v[160:161], v219 offset:1024
    ds_read_b64_tr_b16 v[162:163], v130 offset:0
    ds_read_b64_tr_b16 v[164:165], v130 offset:1024
    ds_read_b64_tr_b16 v[166:167], v131 offset:0
    ds_read_b64_tr_b16 v[168:169], v131 offset:1024
    ds_read_b64_tr_b16 v[170:171], v130 offset:2048
    ds_read_b64_tr_b16 v[172:173], v130 offset:3072
    ds_read_b64_tr_b16 v[174:175], v131 offset:2048
    ds_read_b64_tr_b16 v[176:177], v131 offset:3072
    ds_read_b64_tr_b16 v[178:179], v218 offset:8192
    ds_read_b64_tr_b16 v[180:181], v218 offset:9216
    ds_read_b64_tr_b16 v[182:183], v219 offset:8192
    ds_read_b64_tr_b16 v[184:185], v219 offset:9216
    ds_read_b64_tr_b16 v[186:187], v218 offset:16384
    ds_read_b64_tr_b16 v[188:189], v218 offset:17408
    ds_read_b64_tr_b16 v[190:191], v219 offset:16384
    ds_read_b64_tr_b16 v[192:193], v219 offset:17408
    ds_read_b64_tr_b16 v[194:195], v130 offset:16384
    ds_read_b64_tr_b16 v[196:197], v130 offset:17408
    ds_read_b64_tr_b16 v[198:199], v131 offset:16384
    ds_read_b64_tr_b16 v[200:201], v131 offset:17408
    ds_read_b64_tr_b16 v[202:203], v130 offset:18432
    ds_read_b64_tr_b16 v[204:205], v130 offset:19456
    ds_read_b64_tr_b16 v[206:207], v131 offset:18432
    ds_read_b64_tr_b16 v[208:209], v131 offset:19456
    ds_read_b64_tr_b16 v[210:211], v218 offset:24576
    ds_read_b64_tr_b16 v[212:213], v218 offset:25600
    ds_read_b64_tr_b16 v[214:215], v219 offset:24576
    ds_read_b64_tr_b16 v[216:217], v219 offset:25600
    s_waitcnt lgkmcnt(0)
    s_mov_b32 s45, 200000
L_sv_h0_spin:
    s_load_dwordx2 s[72:73], s[32:33], 0 glc
    s_load_dwordx2 s[74:75], s[32:33], 64 glc
    s_load_dwordx2 s[76:77], s[32:33], 128 glc
    s_load_dwordx2 s[78:79], s[32:33], 192 glc
    s_waitcnt lgkmcnt(0)
    s_min_u32 s42, s72, s73
    s_min_u32 s42, s42, s74
    s_min_u32 s42, s42, s75
    s_min_u32 s42, s42, s76
    s_min_u32 s42, s42, s77
    s_min_u32 s42, s42, s78
    s_min_u32 s42, s42, s79
    s_max_u32 s101, s101, s42
    s_cmp_ge_u32 s101, 1
    s_cbranch_scc1 L_sv_h0_done
    s_sleep 2
    s_sub_u32 s45, s45, 1
    s_cmp_lg_u32 s45, 0
    s_cbranch_scc1 L_sv_h0_spin
L_sv_h0_done:
    s_add_u32 m0, s81, 32768
    s_lshl4_add_u32 s89, s93, s98
    buffer_load_dwordx4 v128, s[24:27], s89 offen lds
    buffer_load_dwordx4 v129, s[24:27], s89 offen offset:1024 lds
    s_add_u32 m0, s81, 34816
    s_lshl4_add_u32 s89, s94, s98
    buffer_load_dwordx4 v128, s[24:27], s89 offen lds
    buffer_load_dwordx4 v129, s[24:27], s89 offen offset:1024 lds
    s_add_u32 m0, s80, 49152
    s_lshl4_add_u32 s89, s95, s98
    buffer_load_dwordx4 v128, s[24:27], s89 offen lds
    buffer_load_dwordx4 v129, s[24:27], s89 offen offset:1024 lds
    s_add_u32 m0, s81, 0
    s_lshl4_add_u32 s89, s96, s98
    buffer_load_dwordx4 v128, s[24:27], s89 offen lds
    buffer_load_dwordx4 v129, s[24:27], s89 offen offset:1024 lds
    s_add_u32 m0, s81, 2048
    s_lshl4_add_u32 s89, s90, s99
    buffer_load_dwordx4 v128, s[24:27], s89 offen lds
    buffer_load_dwordx4 v129, s[24:27], s89 offen offset:1024 lds
    s_add_u32 m0, s80, 57344
    s_lshl4_add_u32 s89, s91, s99
    buffer_load_dwordx4 v128, s[24:27], s89 offen lds
    buffer_load_dwordx4 v129, s[24:27], s89 offen offset:1024 lds
    s_add_u32 m0, s80, 65536
    s_lshl4_add_u32 s89, s92, s99
    buffer_load_dwordx4 v128, s[24:27], s89 offen lds
    buffer_load_dwordx4 v129, s[24:27], s89 offen offset:1024 lds
    s_add_u32 m0, s81, 16384
    s_lshl4_add_u32 s89, s93, s99
    buffer_load_dwordx4 v128, s[24:27], s89 offen lds
    buffer_load_dwordx4 v129, s[24:27], s89 offen offset:1024 lds
    s_add_u32 m0, s81, 18432
    s_lshl4_add_u32 s89, s94, s99
    buffer_load_dwordx4 v128, s[24:27], s89 offen lds
    buffer_load_dwordx4 v129, s[24:27], s89 offen offset:1024 lds
    s_add_u32 m0, s80, 73728
    s_lshl4_add_u32 s89, s95, s99
    buffer_load_dwordx4 v128, s[24:27], s89 offen lds
    buffer_load_dwordx4 v129, s[24:27], s89 offen offset:1024 lds
    s_load_dwordx2 s[14:15], s[32:33], 0 glc
    s_load_dwordx2 s[16:17], s[32:33], 64 glc
    s_load_dwordx2 s[18:19], s[32:33], 128 glc
    s_load_dwordx2 s[20:21], s[32:33], 192 glc
    buffer_load_dwordx4 v[220:223], v132, s[60:63], s90 offen offset:0 sc1
    buffer_load_dwordx4 v[224:227], v133, s[60:63], s90 offen offset:0 sc1
    buffer_load_dwordx4 v[228:231], v132, s[60:63], s91 offen offset:0 sc1
    buffer_load_dwordx4 v[232:235], v133, s[60:63], s91 offen offset:0 sc1
    buffer_load_dwordx4 v[96:99], v132, s[60:63], s92 offen offset:0 sc1
    buffer_load_dwordx4 v[100:103], v133, s[60:63], s92 offen offset:0 sc1
    buffer_load_dwordx4 v[120:123], v132, s[60:63], s93 offen offset:0 sc1
    buffer_load_dwordx4 v[124:127], v133, s[60:63], s93 offen offset:0 sc1
    buffer_load_dwordx4 v[104:107], v132, s[60:63], s94 offen offset:0 sc1
    buffer_load_dwordx4 v[108:111], v133, s[60:63], s94 offen offset:0 sc1
L_g2:
    s_waitcnt vmcnt(9)
    v_mfma_f32_32x32x16_bf16 v[32:47], v[138:141], v[220:223], 0
    buffer_load_dwordx4 v[112:115], v132, s[60:63], s95 offen offset:0 sc1
    v_mfma_f32_32x32x16_bf16 v[48:63], v[142:145], v[220:223], 0
    buffer_load_dwordx4 v[116:119], v133, s[60:63], s95 offen offset:0 sc1
    s_waitcnt vmcnt(10)
    v_mfma_f32_32x32x16_bf16 v[64:79], v[138:141], v[224:227], 0
    v_mfma_f32_32x32x16_bf16 v[80:95], v[142:145], v[224:227], 0
    s_waitcnt vmcnt(9)
    v_mfma_f32_32x32x16_bf16 v[32:47], v[146:149], v[228:231], v[32:47]
    buffer_load_dwordx4 v[220:223], v132, s[60:63], s96 offen offset:0 sc1
    v_mfma_f32_32x32x16_bf16 v[48:63], v[150:153], v[228:231], v[48:63]
    buffer_load_dwordx4 v[224:227], v133, s[60:63], s96 offen offset:0 sc1
    s_waitcnt vmcnt(10)
    v_mfma_f32_32x32x16_bf16 v[64:79], v[146:149], v[232:235], v[64:79]
    v_mfma_f32_32x32x16_bf16 v[80:95], v[150:153], v[232:235], v[80:95]
    s_waitcnt lgkmcnt(0)
    s_min_u32 s42, s14, s15
    s_min_u32 s42, s42, s16
    s_min_u32 s42, s42, s17
    s_min_u32 s42, s42, s18
    s_min_u32 s42, s42, s19
    s_min_u32 s42, s42, s20
    s_min_u32 s42, s42, s21
    s_max_u32 s101, s101, s42
    s_cmp_ge_u32 s101, 2
    s_cbranch_scc0 L_g2_h1_slow
L_g2_h1_back:
    s_load_dwordx2 s[6:7], s[32:33], 0 glc
    s_load_dwordx2 s[8:9], s[32:33], 64 glc
    s_load_dwordx2 s[10:11], s[32:33], 128 glc
    s_load_dwordx2 s[12:13], s[32:33], 192 glc
    s_waitcnt vmcnt(9)
    v_mfma_f32_32x32x16_bf16 v[32:47], v[154:157], v[96:99], v[32:47]
    buffer_load_dwordx4 v[228:231], v132, s[60:63], s90 offen offset:1024 sc1
    v_mfma_f32_32x32x16_bf16 v[48:63], v[158:161], v[96:99], v[48:63]
    buffer_load_dwordx4 v[232:235], v133, s[60:63], s90 offen offset:1024 sc1
    s_waitcnt vmcnt(10)
    v_mfma_f32_32x32x16_bf16 v[64:79], v[154:157], v[100:103], v[64:79]
    v_mfma_f32_32x32x16_bf16 v[80:95], v[158:161], v[100:103], v[80:95]
    s_waitcnt vmcnt(9)
    v_mfma_f32_32x32x16_bf16 v[32:47], v[162:165], v[120:123], v[32:47]
    buffer_load_dwordx4 v[96:99], v132, s[60:63], s91 offen offset:1024 sc1
    v_mfma_f32_32x32x16_bf16 v[48:63], v[166:169], v[120:123], v[48:63]
    buffer_load_dwordx4 v[100:103], v133, s[60:63], s91 offen offset:1024 sc1
    s_waitcnt vmcnt(10)
    v_mfma_f32_32x32x16_bf16 v[64:79], v[162:165], v[124:127], v[64:79]
    v_mfma_f32_32x32x16_bf16 v[80:95], v[166:169], v[124:127], v[80:95]
    s_waitcnt vmcnt(9)
    v_mfma_f32_32x32x16_bf16 v[32:47], v[170:173], v[104:107], v[32:47]
    buffer_load_dwordx4 v[120:123], v132, s[60:63], s92 offen offset:1024 sc1
    v_mfma_f32_32x32x16_bf16 v[48:63], v[174:177], v[104:107], v[48:63]
    buffer_load_dwordx4 v[124:127], v133, s[60:63], s92 offen offset:1024 sc1
    s_waitcnt vmcnt(10)
    v_mfma_f32_32x32x16_bf16 v[64:79], v[170:173], v[108:111], v[64:79]
    v_mfma_f32_32x32x16_bf16 v[80:95], v[174:177], v[108:111], v[80:95]
    s_waitcnt vmcnt(9)
    v_mfma_f32_32x32x16_bf16 v[32:47], v[178:181], v[112:115], v[32:47]
    buffer_load_dwordx4 v[104:107], v132, s[60:63], s93 offen offset:1024 sc1
    v_mfma_f32_32x32x16_bf16 v[48:63], v[182:185], v[112:115], v[48:63]
    buffer_load_dwordx4 v[108:111], v133, s[60:63], s93 offen offset:1024 sc1
    s_waitcnt vmcnt(10)
    v_mfma_f32_32x32x16_bf16 v[64:79], v[178:181], v[116:119], v[64:79]
    buffer_load_dwordx4 v[170:173], v132, s[60:63], s94 offen offset:1024 sc1
    v_mfma_f32_32x32x16_bf16 v[80:95], v[182:185], v[116:119], v[80:95]
    buffer_load_dwordx4 v[174:177], v133, s[60:63], s94 offen offset:1024 sc1
    s_waitcnt vmcnt(11)
    v_mfma_f32_32x32x16_bf16 v[32:47], v[186:189], v[220:223], v[32:47]
    buffer_load_dwordx4 v[112:115], v132, s[60:63], s95 offen offset:1024 sc1
    v_mfma_f32_32x32x16_bf16 v[48:63], v[190:193], v[220:223], v[48:63]
    buffer_load_dwordx4 v[116:119], v133, s[60:63], s95 offen offset:1024 sc1
    s_waitcnt vmcnt(12)
    v_mfma_f32_32x32x16_bf16 v[64:79], v[186:189], v[224:227], v[64:79]
    buffer_load_dwordx4 v[178:181], v132, s[60:63], s96 offen offset:1024 sc1
    v_mfma_f32_32x32x16_bf16 v[80:95], v[190:193], v[224:227], v[80:95]
    buffer_load_dwordx4 v[182:185], v133, s[60:63], s96 offen offset:1024 sc1
    s_cmp_ge_u32 s101, 3
    s_cbranch_scc0 L_g2_h2_slow
L_g2_h2_back:
    s_waitcnt vmcnt(13)
    v_mfma_f32_32x32x16_bf16 v[32:47], v[194:197], v[228:231], v[32:47]
    buffer_load_dwordx4 v[220:223], v134, s[60:63], s90 offen offset:0 sc1
    v_mfma_f32_32x32x16_bf16 v[48:63], v[198:201], v[228:231], v[48:63]
    buffer_load_dwordx4 v[224:227], v135, s[60:63], s90 offen offset:0 sc1
    s_waitcnt vmcnt(14)
    v_mfma_f32_32x32x16_bf16 v[64:79], v[194:197], v[232:235], v[64:79]
    buffer_load_dwordx4 v[186:189], v134, s[60:63], s91 offen offset:0 sc1
    v_mfma_f32_32x32x16_bf16 v[80:95], v[198:201], v[232:235], v[80:95]
    buffer_load_dwordx4 v[190:193], v135, s[60:63], s91 offen offset:0 sc1
    s_waitcnt vmcnt(15)
    v_mfma_f32_32x32x16_bf16 v[32:47], v[202:205], v[96:99], v[32:47]
    buffer_load_dwordx4 v[228:231], v134, s[60:63], s92 offen offset:0 sc1
    v_mfma_f32_32x32x16_bf16 v[48:63], v[206:209], v[96:99], v[48:63]
    buffer_load_dwordx4 v[232:235], v135, s[60:63], s92 offen offset:0 sc1
    s_waitcnt vmcnt(16)
    v_mfma_f32_32x32x16_bf16 v[64:79], v[202:205], v[100:103], v[64:79]
    buffer_load_dwordx4 v[194:197], v134, s[60:63], s93 offen offset:0 sc1
    v_mfma_f32_32x32x16_bf16 v[80:95], v[206:209], v[100:103], v[80:95]
    buffer_load_dwordx4 v[198:201], v135, s[60:63], s93 offen offset:0 sc1
    s_waitcnt vmcnt(17)
    v_mfma_f32_32x32x16_bf16 v[32:47], v[210:213], v[120:123], v[32:47]
    buffer_load_dwordx4 v[96:99], v134, s[60:63], s94 offen offset:0 sc1
    ds_read_b64_tr_b16 v[236:237], v130 offset:32768
    ds_read_b64_tr_b16 v[238:239], v130 offset:33792
    v_mfma_f32_32x32x16_bf16 v[48:63], v[214:217], v[120:123], v[48:63]
    buffer_load_dwordx4 v[100:103], v135, s[60:63], s94 offen offset:0 sc1
    ds_read_b64_tr_b16 v[240:241], v131 offset:32768
    ds_read_b64_tr_b16 v[242:243], v131 offset:33792
    s_waitcnt vmcnt(18)
    v_mfma_f32_32x32x16_bf16 v[64:79], v[210:213], v[124:127], v[64:79]
    buffer_load_dwordx4 v[202:205], v134, s[60:63], s95 offen offset:0 sc1
    v_mfma_f32_32x32x16_bf16 v[80:95], v[214:217], v[124:127], v[80:95]
    buffer_load_dwordx4 v[206:209], v135, s[60:63], s95 offen offset:0 sc1
    s_waitcnt lgkmcnt(0)
    s_min_u32 s42, s6, s7
    s_min_u32 s42, s42, s8
    s_min_u32 s42, s42, s9
    s_min_u32 s42, s42, s10
    s_min_u32 s42, s42, s11
    s_min_u32 s42, s42, s12
    s_min_u32 s42, s42, s13
    s_max_u32 s101, s101, s42
    s_cmp_ge_u32 s101, 4
    s_cbranch_scc0 L_g2_h3_slow
L_g2_h3_back:
    s_waitcnt vmcnt(19)
    v_mfma_f32_32x32x16_bf16 v[32:47], v[236:239], v[104:107], v[32:47]
    buffer_load_dwordx4 v[120:123], v134, s[60:63], s96 offen offset:0 sc1
    ds_read_b64_tr_b16 v[244:245], v130 offset:34816
    ds_read_b64_tr_b16 v[246:247], v130 offset:35840
    v_mfma_f32_32x32x16_bf16 v[48:63], v[240:243], v[104:107], v[48:63]
    buffer_load_dwordx4 v[124:127], v135, s[60:63], s96 offen offset:0 sc1
    ds_read_b64_tr_b16 v[248:249], v131 offset:34816
    ds_read_b64_tr_b16 v[250:251], v131 offset:35840
    s_waitcnt vmcnt(20)
    v_mfma_f32_32x32x16_bf16 v[64:79], v[236:239], v[108:111], v[64:79]
    buffer_load_dwordx4 v[210:213], v134, s[60:63], s90 offen offset:1024 sc1
    v_mfma_f32_32x32x16_bf16 v[80:95], v[240:243], v[108:111], v[80:95]
    buffer_load_dwordx4 v[214:217], v135, s[60:63], s90 offen offset:1024 sc1
    s_waitcnt vmcnt(21)
    s_waitcnt lgkmcnt(2)
    v_mfma_f32_32x32x16_bf16 v[32:47], v[244:247], v[170:173], v[32:47]
    buffer_load_dwordx4 v[104:107], v134, s[60:63], s91 offen offset:1024 sc1
    ds_read_b64_tr_b16 v[236:237], v218 offset:0
    ds_read_b64_tr_b16 v[238:239], v218 offset:1024
    s_waitcnt lgkmcnt(2)
    v_mfma_f32_32x32x16_bf16 v[48:63], v[248:251], v[170:173], v[48:63]
    buffer_load_dwordx4 v[108:111], v135, s[60:63], s91 offen offset:1024 sc1
    ds_read_b64_tr_b16 v[240:241], v219 offset:0
    ds_read_b64_tr_b16 v[242:243], v219 offset:1024
    s_waitcnt vmcnt(22)
    v_mfma_f32_32x32x16_bf16 v[64:79], v[244:247], v[174:177], v[64:79]
    v_mfma_f32_32x32x16_bf16 v[80:95], v[248:251], v[174:177], v[80:95]
    s_add_u32 m0, s81, 32768
    s_lshl4_add_u32 s89, s96, s99
    buffer_load_dwordx4 v128, s[24:27], s89 offen lds
    buffer_load_dwordx4 v129, s[24:27], s89 offen offset:1024 lds
    s_waitcnt vmcnt(23)
    s_waitcnt lgkmcnt(2)
    v_mfma_f32_32x32x16_bf16 v[32:47], v[236:239], v[112:115], v[32:47]
    buffer_load_dwordx4 v[170:173], v134, s[60:63], s92 offen offset:1024 sc1
    ds_read_b64_tr_b16 v[244:245], v130 offset:0
    ds_read_b64_tr_b16 v[246:247], v130 offset:1024
    s_waitcnt lgkmcnt(2)
    v_mfma_f32_32x32x16_bf16 v[48:63], v[240:243], v[112:115], v[48:63]
    buffer_load_dwordx4 v[174:177], v135, s[60:63], s92 offen offset:1024 sc1
    ds_read_b64_tr_b16 v[248:249], v131 offset:0
    ds_read_b64_tr_b16 v[250:251], v131 offset:1024
    s_waitcnt vmcnt(24)
    v_mfma_f32_32x32x16_bf16 v[64:79], v[236:239], v[116:119], v[64:79]
    v_mfma_f32_32x32x16_bf16 v[80:95], v[240:243], v[116:119], v[80:95]
    s_add_u32 m0, s81, 34816
    s_lshl4_add_u32 s89, s90, s100
    buffer_load_dwordx4 v128, s[24:27], s89 offen lds
    buffer_load_dwordx4 v129, s[24:27], s89 offen offset:1024 lds
    s_waitcnt vmcnt(25)
    s_waitcnt lgkmcnt(2)
    v_mfma_f32_32x32x16_bf16 v[32:47], v[244:247], v[178:181], v[32:47]
    buffer_load_dwordx4 v[112:115], v134, s[60:63], s93 offen offset:1024 sc1
    ds_read_b64_tr_b16 v[236:237], v130 offset:2048
    ds_read_b64_tr_b16 v[238:239], v130 offset:3072
    s_waitcnt lgkmcnt(2)
    v_mfma_f32_32x32x16_bf16 v[48:63], v[248:251], v[178:181], v[48:63]
    buffer_load_dwordx4 v[116:119], v135, s[60:63], s93 offen offset:1024 sc1
    ds_read_b64_tr_b16 v[240:241], v131 offset:2048
    ds_read_b64_tr_b16 v[242:243], v131 offset:3072
    s_waitcnt vmcnt(26)
    v_mfma_f32_32x32x16_bf16 v[64:79], v[244:247], v[182:185], v[64:79]
    v_mfma_f32_32x32x16_bf16 v[80:95], v[248:251], v[182:185], v[80:95]
    s_add_u32 m0, s80, 49152
    s_lshl4_add_u32 s89, s91, s100
    buffer_load_dwordx4 v128, s[24:27], s89 offen lds
    buffer_load_dwordx4 v129, s[24:27], s89 offen offset:1024 lds
    s_waitcnt vmcnt(27)
    s_waitcnt lgkmcnt(2)
    v_mfma_f32_32x32x16_bf16 v[32:47], v[236:239], v[220:223], v[32:47]
    buffer_load_dwordx4 v[178:181], v134, s[60:63], s94 offen offset:1024 sc1
    ds_read_b64_tr_b16 v[244:245], v218 offset:8192
    ds_read_b64_tr_b16 v[246:247], v218 offset:9216
    s_waitcnt lgkmcnt(2)
    v_mfma_f32_32x32x16_bf16 v[48:63], v[240:243], v[220:223], v[48:63]
    buffer_load_dwordx4 v[182:185], v135, s[60:63], s94 offen offset:1024 sc1
    ds_read_b64_tr_b16 v[248:249], v219 offset:8192
    ds_read_b64_tr_b16 v[250:251], v219 offset:9216
    s_waitcnt vmcnt(28)
    v_mfma_f32_32x32x16_bf16 v[64:79], v[236:239], v[224:227], v[64:79]
    v_mfma_f32_32x32x16_bf16 v[80:95], v[240:243], v[224:227], v[80:95]
    s_add_u32 m0, s81, 0
    s_lshl4_add_u32 s89, s92, s100
    buffer_load_dwordx4 v128, s[24:27], s89 offen lds
    buffer_load_dwordx4 v129, s[24:27], s89 offen offset:1024 lds
    s_waitcnt vmcnt(29)
    s_waitcnt lgkmcnt(2)
    v_mfma_f32_32x32x16_bf16 v[32:47], v[244:247], v[186:189], v[32:47]
    buffer_load_dwordx4 v[220:223], v134, s[60:63], s95 offen offset:1024 sc1
    ds_read_b64_tr_b16 v[236:237], v218 offset:16384
    ds_read_b64_tr_b16 v[238:239], v218 offset:17408
    s_waitcnt lgkmcnt(2)
    v_mfma_f32_32x32x16_bf16 v[48:63], v[248:251], v[186:189], v[48:63]
    buffer_load_dwordx4 v[224:227], v135, s[60:63], s95 offen offset:1024 sc1
    ds_read_b64_tr_b16 v[240:241], v219 offset:16384
    ds_read_b64_tr_b16 v[242:243], v219 offset:17408
    s_waitcnt vmcnt(30)
    v_mfma_f32_32x32x16_bf16 v[64:79], v[244:247], v[190:193], v[64:79]
    v_mfma_f32_32x32x16_bf16 v[80:95], v[248:251], v[190:193], v[80:95]
    s_add_u32 m0, s81, 2048
    s_lshl4_add_u32 s89, s93, s100
    buffer_load_dwordx4 v128, s[24:27], s89 offen lds
    buffer_load_dwordx4 v129, s[24:27], s89 offen offset:1024 lds
    s_mov_b32 exec_lo, 0xffffffff
    s_mov_b32 exec_hi, 0xff
    buffer_load_dword v20, v137, s[64:67], 0 offen offset:0 sc1
    s_mov_b64 exec, -1
    s_waitcnt vmcnt(32)
    s_waitcnt lgkmcnt(2)
    v_mfma_f32_32x32x16_bf16 v[32:47], v[236:239], v[228:231], v[32:47]
    buffer_load_dwordx4 v[186:189], v134, s[60:63], s96 offen offset:1024 sc1
    ds_read_b64_tr_b16 v[244:245], v130 offset:16384
    ds_read_b64_tr_b16 v[246:247], v130 offset:17408
    s_waitcnt lgkmcnt(2)
    v_mfma_f32_32x32x16_bf16 v[48:63], v[240:243], v[228:231], v[48:63]
    buffer_load_dwordx4 v[190:193], v135, s[60:63], s96 offen offset:1024 sc1
    ds_read_b64_tr_b16 v[248:249], v131 offset:16384
    ds_read_b64_tr_b16 v[250:251], v131 offset:17408
    s_waitcnt vmcnt(33)
    v_mfma_f32_32x32x16_bf16 v[64:79], v[236:239], v[232:235], v[64:79]
    v_mfma_f32_32x32x16_bf16 v[80:95], v[240:243], v[232:235], v[80:95]
    s_add_u32 m0, s80, 57344
    s_lshl4_add_u32 s89, s94, s100
    buffer_load_dwordx4 v128, s[24:27], s89 offen lds
    buffer_load_dwordx4 v129, s[24:27], s89 offen offset:1024 lds
    s_waitcnt vmcnt(34)
    s_waitcnt lgkmcnt(2)
    v_mfma_f32_32x32x16_bf16 v[32:47], v[244:247], v[194:197], v[32:47]
    ds_read_b64_tr_b16 v[236:237], v130 offset:18432
    ds_read_b64_tr_b16 v[238:239], v130 offset:19456
    s_waitcnt lgkmcnt(2)
    v_mfma_f32_32x32x16_bf16 v[48:63], v[248:251], v[194:197], v[48:63]
    ds_read_b64_tr_b16 v[240:241], v131 offset:18432
    ds_read_b64_tr_b16 v[242:243], v131 offset:19456
    s_waitcnt vmcnt(33)
    v_mfma_f32_32x32x16_bf16 v[64:79], v[244:247], v[198:201], v[64:79]
    v_mfma_f32_32x32x16_bf16 v[80:95], v[248:251], v[198:201], v[80:95]
    s_add_u32 m0, s80, 65536
    s_lshl4_add_u32 s89, s95, s100
    buffer_load_dwordx4 v128, s[24:27], s89 offen lds
    buffer_load_dwordx4 v129, s[24:27], s89 offen offset:1024 lds
    s_waitcnt vmcnt(34)
    s_waitcnt lgkmcnt(2)
    v_mfma_f32_32x32x16_bf16 v[32:47], v[236:239], v[96:99], v[32:47]
    ds_read_b64_tr_b16 v[244:245], v218 offset:24576
    ds_read_b64_tr_b16 v[246:247], v218 offset:25600
    s_waitcnt lgkmcnt(2)
    v_mfma_f32_32x32x16_bf16 v[48:63], v[240:243], v[96:99], v[48:63]
    ds_read_b64_tr_b16 v[248:249], v219 offset:24576
    ds_read_b64_tr_b16 v[250:251], v219 offset:25600
    s_waitcnt vmcnt(33)
    v_mfma_f32_32x32x16_bf16 v[64:79], v[236:239], v[100:103], v[64:79]
    v_mfma_f32_32x32x16_bf16 v[80:95], v[240:243], v[100:103], v[80:95]
    s_add_u32 m0, s81, 16384
    s_lshl4_add_u32 s89, s96, s100
    buffer_load_dwordx4 v128, s[24:27], s89 offen lds
    buffer_load_dwordx4 v129, s[24:27], s89 offen offset:1024 lds
    s_waitcnt vmcnt(25)
    s_waitcnt lgkmcnt(2)
    v_mfma_f32_32x32x16_bf16 v[32:47], v[244:247], v[202:205], v[32:47]
    ds_read_b64_tr_b16 v[236:237], v130 offset:32768
    ds_read_b64_tr_b16 v[238:239], v130 offset:33792
    s_waitcnt lgkmcnt(2)
    v_mfma_f32_32x32x16_bf16 v[48:63], v[248:251], v[202:205], v[48:63]
    ds_read_b64_tr_b16 v[240:241], v131 offset:32768
    ds_read_b64_tr_b16 v[242:243], v131 offset:33792
    v_mfma_f32_32x32x16_bf16 v[64:79], v[244:247], v[206:209], v[64:79]
    v_mfma_f32_32x32x16_bf16 v[80:95], v[248:251], v[206:209], v[80:95]
    s_waitcnt vmcnt(21)
    s_waitcnt vmcnt(8)
    s_mov_b32 exec_lo, 0xffffffff
    s_mov_b32 exec_hi, 0xff
    v_cmp_eq_u32 vcc, 1, v20
    s_mov_b64 s[46:47], exec
    s_mov_b64 exec, -1
    s_nop 1
    s_cmp_eq_u64 vcc, s[46:47]
    s_cbranch_scc0 L_g2_t_slow
L_g2_t_back:
    v_and_b32 v16, 31, v1
    v_lshrrev_b32 v17, 5, v1
    s_lshl_b32 s42, s87, 6
    s_lshl_b32 s43, s83, 5
    s_add_u32 s42, s42, s43
    v_add_u32 v16, s42, v16
    v_lshlrev_b32 v18, 2, v16
    v_add_u32 v18, 0xb00000, v18
    buffer_load_dword v154, v18, s[48:51], 0 offen sc1
    s_lshl_b32 s42, s88, 6
    s_lshl_b32 s43, s82, 5
    s_add_u32 s85, s42, s43
    v_lshlrev_b32 v18, 2, v17
    v_add_u32 v18, s85, v18
    v_lshlrev_b32 v19, 1, v18
    global_load_dwordx2 v[156:157], v19, s[30:31] offset:0
    global_load_dwordx2 v[158:159], v19, s[30:31] offset:16
    global_load_dwordx2 v[160:161], v19, s[30:31] offset:32
    global_load_dwordx2 v[162:163], v19, s[30:31] offset:48
    v_lshrrev_b32 v18, 2, v1
    v_and_b32 v19, 3, v1
    v_add_u32 v2, s85, v18
    v_lshlrev_b32 v2, 12, v2
    v_lshl_add_u32 v2, v19, 4, v2
    s_lshl_b32 s42, s87, 7
    s_lshl_b32 s43, s83, 6
    s_add_u32 s42, s42, s43
    s_add_u32 s42, s42, 0x200000
    s_add_u32 s43, s42, 65536
    buffer_load_dwordx4 v[138:141], v2, s[48:51], s42 offen sc1
    buffer_load_dwordx4 v[142:145], v2, s[48:51], s43 offen sc1
    s_add_u32 s42, s80, 73728
    v_lshlrev_b32 v3, 6, v18
    v_lshl_add_u32 v3, v19, 4, v3
    v_add_u32 v3, s42, v3
    v_lshrrev_b32 v4, 4, v1
    v_and_b32 v5, 15, v1
    v_lshrrev_b32 v6, 1, v4
    v_lshrrev_b32 v7, 2, v5
    v_lshl_add_u32 v6, v6, 2, v7
    v_lshlrev_b32 v6, 6, v6
    v_and_b32 v4, 1, v4
    v_lshl_add_u32 v6, v4, 5, v6
    v_and_b32 v5, 3, v5
    v_lshl_add_u32 v6, v5, 3, v6
    v_add_u32 v4, s42, v6
    s_waitcnt lgkmcnt(2)
    v_mfma_f32_32x32x16_bf16 v[32:47], v[236:239], v[120:123], v[32:47]
    ds_read_b64_tr_b16 v[244:245], v130 offset:34816
    ds_read_b64_tr_b16 v[246:247], v130 offset:35840
    s_waitcnt lgkmcnt(2)
    v_mfma_f32_32x32x16_bf16 v[48:63], v[240:243], v[120:123], v[48:63]
    ds_read_b64_tr_b16 v[248:249], v131 offset:34816
    ds_read_b64_tr_b16 v[250:251], v131 offset:35840
    v_mfma_f32_32x32x16_bf16 v[64:79], v[236:239], v[124:127], v[64:79]
    v_mfma_f32_32x32x16_bf16 v[80:95], v[240:243], v[124:127], v[80:95]
    s_waitcnt lgkmcnt(2)
    v_mfma_f32_32x32x16_bf16 v[32:47], v[244:247], v[210:213], v[32:47]
    ds_read_b64_tr_b16 v[236:237], v218 offset:0
    ds_read_b64_tr_b16 v[238:239], v218 offset:1024
    s_waitcnt lgkmcnt(2)
    v_mfma_f32_32x32x16_bf16 v[48:63], v[248:251], v[210:213], v[48:63]
    ds_read_b64_tr_b16 v[240:241], v219 offset:0
    ds_read_b64_tr_b16 v[242:243], v219 offset:1024
    v_mfma_f32_32x32x16_bf16 v[64:79], v[244:247], v[214:217], v[64:79]
    v_mfma_f32_32x32x16_bf16 v[80:95], v[248:251], v[214:217], v[80:95]
    s_waitcnt lgkmcnt(2)
    v_mfma_f32_32x32x16_bf16 v[32:47], v[236:239], v[104:107], v[32:47]
    ds_read_b64_tr_b16 v[244:245], v130 offset:0
    ds_read_b64_tr_b16 v[246:247], v130 offset:1024
    s_waitcnt lgkmcnt(2)
    v_mfma_f32_32x32x16_bf16 v[48:63], v[240:243], v[104:107], v[48:63]
    ds_read_b64_tr_b16 v[248:249], v131 offset:0
    ds_read_b64_tr_b16 v[250:251], v131 offset:1024
    v_mfma_f32_32x32x16_bf16 v[64:79], v[236:239], v[108:111], v[64:79]
    v_mfma_f32_32x32x16_bf16 v[80:95], v[240:243], v[108:111], v[80:95]
    s_waitcnt lgkmcnt(2)
    v_mfma_f32_32x32x16_bf16 v[32:47], v[244:247], v[170:173], v[32:47]
    ds_read_b64_tr_b16 v[236:237], v130 offset:2048
    ds_read_b64_tr_b16 v[238:239], v130 offset:3072
    s_waitcnt lgkmcnt(2)
    v_mfma_f32_32x32x16_bf16 v[48:63], v[248:251], v[170:173], v[48:63]
    ds_read_b64_tr_b16 v[240:241], v131 offset:2048
    ds_read_b64_tr_b16 v[242:243], v131 offset:3072
    v_mfma_f32_32x32x16_bf16 v[64:79], v[244:247], v[174:177], v[64:79]
    v_mfma_f32_32x32x16_bf16 v[80:95], v[248:251], v[174:177], v[80:95]
    s_waitcnt vmcnt(1)
    ds_write_b128 v3, v[138:141]
    s_waitcnt vmcnt(0)
    ds_write_b128 v3, v[142:145] offset:1024
    ds_read_b64_tr_b16 v[146:147], v4 offset:0
    ds_read_b64_tr_b16 v[148:149], v4 offset:512
    ds_read_b64_tr_b16 v[150:151], v4 offset:1024
    ds_read_b64_tr_b16 v[152:153], v4 offset:1536
    s_waitcnt lgkmcnt(8)
    v_mfma_f32_32x32x16_bf16 v[32:47], v[236:239], v[112:115], v[32:47]
    ds_read_b64_tr_b16 v[244:245], v218 offset:8192
    ds_read_b64_tr_b16 v[246:247], v218 offset:9216
    s_waitcnt lgkmcnt(8)
    v_mfma_f32_32x32x16_bf16 v[48:63], v[240:243], v[112:115], v[48:63]
    ds_read_b64_tr_b16 v[248:249], v219 offset:8192
    ds_read_b64_tr_b16 v[250:251], v219 offset:9216
    v_mfma_f32_32x32x16_bf16 v[64:79], v[236:239], v[116:119], v[64:79]
    v_mfma_f32_32x32x16_bf16 v[80:95], v[240:243], v[116:119], v[80:95]
    s_waitcnt lgkmcnt(2)
    v_mfma_f32_32x32x16_bf16 v[32:47], v[244:247], v[178:181], v[32:47]
    ds_read_b64_tr_b16 v[236:237], v218 offset:16384
    ds_read_b64_tr_b16 v[238:239], v218 offset:17408
    v_sub_f32 v20, 1.0, v154
    v_cvt_pk_bf16_f32 v20, v20, v20
    v_lshlrev_b32 v20, 16, v20
    v_lshlrev_b32 v138, 16, v146
    v_and_b32 v139, 0xffff0000, v146
    v_lshlrev_b32 v140, 16, v147
    s_waitcnt lgkmcnt(2)
    v_mfma_f32_32x32x16_bf16 v[48:63], v[248:251], v[178:181], v[48:63]
    ds_read_b64_tr_b16 v[240:241], v219 offset:16384
    ds_read_b64_tr_b16 v[242:243], v219 offset:17408
    v_and_b32 v141, 0xffff0000, v147
    v_lshlrev_b32 v6, 16, v156
    v_and_b32 v7, 0xffff0000, v156
    v_lshlrev_b32 v8, 16, v157
    v_and_b32 v9, 0xffff0000, v157
    v_mul_f32 v138, v138, v154
    v_mfma_f32_32x32x16_bf16 v[64:79], v[244:247], v[182:185], v[64:79]
    v_mul_f32 v139, v139, v154
    v_mul_f32 v140, v140, v154
    v_mul_f32 v141, v141, v154
    v_fmac_f32 v138, v6, v20
    v_fmac_f32 v139, v7, v20
    v_fmac_f32 v140, v8, v20
    v_mfma_f32_32x32x16_bf16 v[80:95], v[248:251], v[182:185], v[80:95]
    v_fmac_f32 v141, v9, v20
    v_lshlrev_b32 v142, 16, v148
    v_and_b32 v143, 0xffff0000, v148
    v_lshlrev_b32 v144, 16, v149
    v_and_b32 v145, 0xffff0000, v149
    v_lshlrev_b32 v6, 16, v158
    s_waitcnt lgkmcnt(2)
    v_mfma_f32_32x32x16_bf16 v[32:47], v[236:239], v[220:223], v[32:47]
    ds_read_b64_tr_b16 v[244:245], v130 offset:16384
    ds_read_b64_tr_b16 v[246:247], v130 offset:17408
    v_and_b32 v7, 0xffff0000, v158
    v_lshlrev_b32 v8, 16, v159
    v_and_b32 v9, 0xffff0000, v159
    v_mul_f32 v142, v142, v154
    v_mul_f32 v143, v143, v154
    v_mul_f32 v144, v144, v154
    s_waitcnt lgkmcnt(2)
    v_mfma_f32_32x32x16_bf16 v[48:63], v[240:243], v[220:223], v[48:63]
    ds_read_b64_tr_b16 v[248:249], v131 offset:16384
    ds_read_b64_tr_b16 v[250:251], v131 offset:17408
    v_mul_f32 v145, v145, v154
    v_fmac_f32 v142, v6, v20
    v_fmac_f32 v143, v7, v20
    v_fmac_f32 v144, v8, v20
    v_fmac_f32 v145, v9, v20
    v_lshlrev_b32 v146, 16, v150
    v_mfma_f32_32x32x16_bf16 v[64:79], v[236:239], v[224:227], v[64:79]
    v_and_b32 v147, 0xffff0000, v150
    v_lshlrev_b32 v148, 16, v151
    v_and_b32 v149, 0xffff0000, v151
    v_lshlrev_b32 v6, 16, v160
    v_and_b32 v7, 0xffff0000, v160
    v_lshlrev_b32 v8, 16, v161
    v_mfma_f32_32x32x16_bf16 v[80:95], v[240:243], v[224:227], v[80:95]
    v_and_b32 v9, 0xffff0000, v161
    v_mul_f32 v146, v146, v154
    v_mul_f32 v147, v147, v154
    v_mul_f32 v148, v148, v154
    v_mul_f32 v149, v149, v154
    v_fmac_f32 v146, v6, v20
    s_waitcnt lgkmcnt(2)
    v_mfma_f32_32x32x16_bf16 v[32:47], v[244:247], v[186:189], v[32:47]
    v_fmac_f32 v147, v7, v20
    v_fmac_f32 v148, v8, v20
    v_fmac_f32 v149, v9, v20
    v_lshlrev_b32 v150, 16, v152
    v_and_b32 v151, 0xffff0000, v152
    v_lshlrev_b32 v152, 16, v153
    s_waitcnt lgkmcnt(0)
    v_mfma_f32_32x32x16_bf16 v[48:63], v[248:251], v[186:189], v[48:63]
    v_and_b32 v153, 0xffff0000, v153
    v_lshlrev_b32 v6, 16, v162
    v_and_b32 v7, 0xffff0000, v162
    v_lshlrev_b32 v8, 16, v163
    v_and_b32 v9, 0xffff0000, v163
    v_mul_f32 v150, v150, v154
    v_mfma_f32_32x32x16_bf16 v[64:79], v[244:247], v[190:193], v[64:79]
    v_mul_f32 v151, v151, v154
    v_mul_f32 v152, v152, v154
    v_mul_f32 v153, v153, v154
    v_fmac_f32 v150, v6, v20
    v_fmac_f32 v151, v7, v20
    v_fmac_f32 v152, v8, v20
    v_mfma_f32_32x32x16_bf16 v[80:95], v[248:251], v[190:193], v[80:95]
    v_fmac_f32 v153, v9, v20
    v_lshlrev_b32 v14, 4, v1
    v_add_u32 v15, s81, v14
    ds_write_b128 v15, v[48:51] offset:32768
    ds_write_b128 v15, v[52:55] offset:33792
    ds_write_b128 v15, v[56:59] offset:34816
    ds_write_b128 v15, v[60:63] offset:35840
    ds_write_b128 v15, v[64:67] offset:0
    ds_write_b128 v15, v[68:71] offset:1024
    ds_write_b128 v15, v[72:75] offset:2048
    ds_write_b128 v15, v[76:79] offset:3072
    s_nop 0
    ds_write_b128 v15, v[80:83] offset:16384
    ds_write_b128 v15, v[84:87] offset:17408
    ds_write_b128 v15, v[88:91] offset:18432
    ds_write_b128 v15, v[92:95] offset:19456
    s_waitcnt lgkmcnt(0)
    s_barrier
    s_xor_b32 s42, s40, 1
    s_lshl_b32 s42, s42, 12
    v_add_u32 v15, s42, v14
    ds_read_b128 v[170:173], v15 offset:32768
    ds_read_b128 v[174:177], v15 offset:33792
    ds_read_b128 v[178:181], v15 offset:34816
    ds_read_b128 v[182:185], v15 offset:35840
    s_xor_b32 s42, s40, 2
    s_lshl_b32 s42, s42, 12
    v_add_u32 v15, s42, v14
    ds_read_b128 v[186:189], v15 offset:0
    ds_read_b128 v[190:193], v15 offset:1024
    ds_read_b128 v[194:197], v15 offset:2048
    ds_read_b128 v[198:201], v15 offset:3072
    s_xor_b32 s42, s40, 3
    s_lshl_b32 s42, s42, 12
    v_add_u32 v15, s42, v14
    ds_read_b128 v[202:205], v15 offset:16384
    ds_read_b128 v[206:209], v15 offset:17408
    ds_read_b128 v[210:213], v15 offset:18432
    ds_read_b128 v[214:217], v15 offset:19456
    v_lshlrev_b32 v16, 10, v16
    s_lshl_b32 s42, s85, 1
    v_add_u32 v16, s42, v16
    v_lshl_add_u32 v16, v17, 4, v16
    s_mov_b32 s52, s34
    s_mov_b32 s53, s35
    s_mov_b32 s54, 0x200000
    s_mov_b32 s55, 0x20000
    s_waitcnt lgkmcnt(11)
    v_add_f32 v32, v32, v170
    v_add_f32 v33, v33, v171
    v_add_f32 v34, v34, v172
    v_add_f32 v35, v35, v173
    s_waitcnt lgkmcnt(10)
    v_add_f32 v36, v36, v174
    v_add_f32 v37, v37, v175
    v_add_f32 v38, v38, v176
    v_add_f32 v39, v39, v177
    s_waitcnt lgkmcnt(9)
    v_add_f32 v40, v40, v178
    v_add_f32 v41, v41, v179
    v_add_f32 v42, v42, v180
    v_add_f32 v43, v43, v181
    s_waitcnt lgkmcnt(8)
    v_add_f32 v44, v44, v182
    v_add_f32 v45, v45, v183
    v_add_f32 v46, v46, v184
    v_add_f32 v47, v47, v185
    s_waitcnt lgkmcnt(7)
    v_add_f32 v32, v32, v186
    v_add_f32 v33, v33, v187
    v_add_f32 v34, v34, v188
    v_add_f32 v35, v35, v189
    s_waitcnt lgkmcnt(6)
    v_add_f32 v36, v36, v190
    v_add_f32 v37, v37, v191
    v_add_f32 v38, v38, v192
    v_add_f32 v39, v39, v193
    s_waitcnt lgkmcnt(5)
    v_add_f32 v40, v40, v194
    v_add_f32 v41, v41, v195
    v_add_f32 v42, v42, v196
    v_add_f32 v43, v43, v197
    s_waitcnt lgkmcnt(4)
    v_add_f32 v44, v44, v198
    v_add_f32 v45, v45, v199
    v_add_f32 v46, v46, v200
    v_add_f32 v47, v47, v201
    s_waitcnt lgkmcnt(3)
    v_add_f32 v32, v32, v202
    v_add_f32 v33, v33, v203
    v_add_f32 v34, v34, v204
    v_add_f32 v35, v35, v205
    s_waitcnt lgkmcnt(2)
    v_add_f32 v36, v36, v206
    v_add_f32 v37, v37, v207
    v_add_f32 v38, v38, v208
    v_add_f32 v39, v39, v209
    s_waitcnt lgkmcnt(1)
    v_add_f32 v40, v40, v210
    v_add_f32 v41, v41, v211
    v_add_f32 v42, v42, v212
    v_add_f32 v43, v43, v213
    s_waitcnt lgkmcnt(0)
    v_add_f32 v44, v44, v214
    v_add_f32 v45, v45, v215
    v_add_f32 v46, v46, v216
    v_add_f32 v47, v47, v217
    v_fmac_f32 v138, v32, v20
    v_fmac_f32 v139, v33, v20
    v_fmac_f32 v140, v34, v20
    v_fmac_f32 v141, v35, v20
    v_fmac_f32 v142, v36, v20
    v_fmac_f32 v143, v37, v20
    v_fmac_f32 v144, v38, v20
    v_fmac_f32 v145, v39, v20
    v_fmac_f32 v146, v40, v20
    v_fmac_f32 v147, v41, v20
    v_fmac_f32 v148, v42, v20
    v_fmac_f32 v149, v43, v20
    v_fmac_f32 v150, v44, v20
    v_fmac_f32 v151, v45, v20
    v_fmac_f32 v152, v46, v20
    v_fmac_f32 v153, v47, v20
    v_cvt_pk_bf16_f32 v96, v138, v139
    v_cvt_pk_bf16_f32 v97, v140, v141
    v_cvt_pk_bf16_f32 v98, v142, v143
    v_cvt_pk_bf16_f32 v99, v144, v145
    v_cvt_pk_bf16_f32 v100, v146, v147
    v_cvt_pk_bf16_f32 v101, v148, v149
    v_cvt_pk_bf16_f32 v102, v150, v151
    v_cvt_pk_bf16_f32 v103, v152, v153
    v_permlane32_swap_b32 v96, v98
    v_permlane32_swap_b32 v97, v99
    buffer_store_dwordx4 v[96:99], v16, s[52:55], 0 offen offset:0
    v_permlane32_swap_b32 v100, v102
    v_permlane32_swap_b32 v101, v103
    buffer_store_dwordx4 v[100:103], v16, s[52:55], 0 offen offset:32
L_exit:
    s_endpgm
L_g1_rdy_slow:
    s_mov_b32 s45, 200000
L_g1_rdys_spin:
    s_mov_b64 exec, 0x1
    buffer_load_dword v31, v28, s[68:71], 0 offen offset:0 sc1
    s_waitcnt vmcnt(0)
    v_cmp_eq_u32 vcc, 1, v31
    s_mov_b64 s[46:47], exec
    s_mov_b64 exec, -1
    s_nop 1
    s_cmp_eq_u64 vcc, s[46:47]
    s_cbranch_scc1 L_g1_rdys_done
    s_sleep 2
    s_sub_u32 s45, s45, 1
    s_cmp_lg_u32 s45, 0
    s_cbranch_scc1 L_g1_rdys_spin
L_g1_rdys_done:
    s_branch L_g1_rdy_back
L_g1_fl_slow:
    s_mov_b32 s45, 200000
L_g1_fls_spin:
    s_mov_b64 exec, 0xffff
    buffer_load_dword v31, v29, s[64:67], 0 offen offset:0 sc1
    s_waitcnt vmcnt(0)
    v_cmp_eq_u32 vcc, 1, v31
    s_mov_b64 s[46:47], exec
    s_mov_b64 exec, -1
    s_nop 1
    s_cmp_eq_u64 vcc, s[46:47]
    s_cbranch_scc1 L_g1_fls_done
    s_sleep 2
    s_sub_u32 s45, s45, 1
    s_cmp_lg_u32 s45, 0
    s_cbranch_scc1 L_g1_fls_spin
L_g1_fls_done:
    s_branch L_g1_fl_back
L_g2_t_slow:
    s_mov_b32 s45, 200000
L_g2_ts_spin:
    s_mov_b32 exec_lo, 0xffffffff
    s_mov_b32 exec_hi, 0xff
    buffer_load_dword v20, v137, s[64:67], 0 offen offset:0 sc1
    s_waitcnt vmcnt(0)
    v_cmp_eq_u32 vcc, 1, v20
    s_mov_b64 s[46:47], exec
    s_mov_b64 exec, -1
    s_nop 1
    s_cmp_eq_u64 vcc, s[46:47]
    s_cbranch_scc1 L_g2_ts_done
    s_sleep 2
    s_sub_u32 s45, s45, 1
    s_cmp_lg_u32 s45, 0
    s_cbranch_scc1 L_g2_ts_spin
L_g2_ts_done:
    s_branch L_g2_t_back
L_g1_h0_slow:
    s_waitcnt lgkmcnt(0)
    s_mov_b32 s45, 200000
L_g1_h0s_spin:
    s_load_dwordx2 s[72:73], s[32:33], 0 glc
    s_load_dwordx2 s[74:75], s[32:33], 64 glc
    s_load_dwordx2 s[76:77], s[32:33], 128 glc
    s_load_dwordx2 s[78:79], s[32:33], 192 glc
    s_waitcnt lgkmcnt(0)
    s_min_u32 s42, s72, s73
    s_min_u32 s42, s42, s74
    s_min_u32 s42, s42, s75
    s_min_u32 s42, s42, s76
    s_min_u32 s42, s42, s77
    s_min_u32 s42, s42, s78
    s_min_u32 s42, s42, s79
    s_max_u32 s101, s101, s42
    s_cmp_ge_u32 s101, 1
    s_cbranch_scc1 L_g1_h0s_done
    s_sleep 2
    s_sub_u32 s45, s45, 1
    s_cmp_lg_u32 s45, 0
    s_cbranch_scc1 L_g1_h0s_spin
L_g1_h0s_done:
    s_branch L_g1_h0_back
L_g2_h1_slow:
    s_waitcnt lgkmcnt(0)
    s_mov_b32 s45, 200000
L_g2_h1s_spin:
    s_load_dwordx2 s[72:73], s[32:33], 0 glc
    s_load_dwordx2 s[74:75], s[32:33], 64 glc
    s_load_dwordx2 s[76:77], s[32:33], 128 glc
    s_load_dwordx2 s[78:79], s[32:33], 192 glc
    s_waitcnt lgkmcnt(0)
    s_min_u32 s42, s72, s73
    s_min_u32 s42, s42, s74
    s_min_u32 s42, s42, s75
    s_min_u32 s42, s42, s76
    s_min_u32 s42, s42, s77
    s_min_u32 s42, s42, s78
    s_min_u32 s42, s42, s79
    s_max_u32 s101, s101, s42
    s_cmp_ge_u32 s101, 2
    s_cbranch_scc1 L_g2_h1s_done
    s_sleep 2
    s_sub_u32 s45, s45, 1
    s_cmp_lg_u32 s45, 0
    s_cbranch_scc1 L_g2_h1s_spin
L_g2_h1s_done:
    s_branch L_g2_h1_back
L_g2_h2_slow:
    s_waitcnt lgkmcnt(0)
    s_mov_b32 s45, 200000
L_g2_h2s_spin:
    s_load_dwordx2 s[72:73], s[32:33], 0 glc
    s_load_dwordx2 s[74:75], s[32:33], 64 glc
    s_load_dwordx2 s[76:77], s[32:33], 128 glc
    s_load_dwordx2 s[78:79], s[32:33], 192 glc
    s_waitcnt lgkmcnt(0)
    s_min_u32 s42, s72, s73
    s_min_u32 s42, s42, s74
    s_min_u32 s42, s42, s75
    s_min_u32 s42, s42, s76
    s_min_u32 s42, s42, s77
    s_min_u32 s42, s42, s78
    s_min_u32 s42, s42, s79
    s_max_u32 s101, s101, s42
    s_cmp_ge_u32 s101, 3
    s_cbranch_scc1 L_g2_h2s_done
    s_sleep 2
    s_sub_u32 s45, s45, 1
    s_cmp_lg_u32 s45, 0
    s_cbranch_scc1 L_g2_h2s_spin
L_g2_h2s_done:
    s_branch L_g2_h2_back
L_g2_h3_slow:
    s_waitcnt lgkmcnt(0)
    s_mov_b32 s45, 200000
L_g2_h3s_spin:
    s_load_dwordx2 s[72:73], s[32:33], 0 glc
    s_load_dwordx2 s[74:75], s[32:33], 64 glc
    s_load_dwordx2 s[76:77], s[32:33], 128 glc
    s_load_dwordx2 s[78:79], s[32:33], 192 glc
    s_waitcnt lgkmcnt(0)
    s_min_u32 s42, s72, s73
    s_min_u32 s42, s42, s74
    s_min_u32 s42, s42, s75
    s_min_u32 s42, s42, s76
    s_min_u32 s42, s42, s77
    s_min_u32 s42, s42, s78
    s_min_u32 s42, s42, s79
    s_max_u32 s101, s101, s42
    s_cmp_ge_u32 s101, 4
    s_cbranch_scc1 L_g2_h3s_done
    s_sleep 2
    s_sub_u32 s45, s45, 1
    s_cmp_lg_u32 s45, 0
    s_cbranch_scc1 L_g2_h3s_spin
L_g2_h3s_done:
    s_branch L_g2_h3_back
L_ssm:
    s_waitcnt lgkmcnt(0)
    s_mov_b32 s41, s2
    s_setprio 3
    s_and_b32 s72, s41, 7
    s_lshr_b32 s73, s41, 3
    s_lshl_b32 s74, s72, 8
    s_lshl_b32 s42, s73, 3
    s_add_u32 s74, s74, s42
    s_lshl_b32 s75, s72, 2
    s_lshr_b32 s42, s73, 3
    s_add_u32 s75, s75, s42
    s_and_b32 s76, s73, 7
    v_lshrrev_b32 v184, 3, v1
    v_and_b32 v185, 7, v1
    s_lshl_b32 s42, s75, 6
    s_lshl_b32 s43, s40, 4
    s_add_u32 s42, s42, s43
    v_add_u32 v4, s42, v184
    v_lshlrev_b32 v4, 10, v4
    v_lshl_add_u32 v4, v185, 4, v4
    s_lshl_b32 s42, s76, 7
    v_add_u32 v4, s42, v4
    global_load_dwordx4 v[160:163], v4, s[4:5]
    v_add_u32 v4, 0x2000, v4
    global_load_dwordx4 v[164:167], v4, s[4:5]
    v_lshrrev_b32 v5, 5, v1
    v_and_b32 v6, 31, v1
    s_lshl_b32 s42, s40, 1
    s_add_u32 s42, s42, s74
    v_add_u32 v186, s42, v5
    v_lshlrev_b32 v8, 10, v186
    v_lshlrev_b32 v9, 5, v6
    v_add_u32 v8, v8, v9
    global_load_dwordx4 v[168:171], v8, s[4:5] offset:0
    global_load_dwordx4 v[172:175], v8, s[4:5] offset:16
    global_load_dwordx4 v[176:179], v9, s[32:33] offset:0
    global_load_dwordx4 v[180:183], v9, s[32:33] offset:16
    s_lshr_b32 s79, s40, 1
    s_and_b32 s80, s40, 1
    s_lshl_b32 s42, s41, 1
    s_add_u32 s81, s42, s79
    s_lshl_b32 s42, s81, 8
    s_lshl_b32 s43, s80, 7
    s_add_u32 s42, s42, s43
    v_lshlrev_b32 v38, 1, v1
    v_add_u32 v38, s42, v38
    global_load_ushort v40, v38, s[6:7]
    global_load_ushort v41, v38, s[8:9]
    global_load_ushort v42, v38, s[10:11]
    global_load_ushort v43, v38, s[12:13]
    global_load_ushort v44, v38, s[14:15]
    global_load_ushort v45, v38, s[16:17]
    s_lshl_b32 s42, s41, 2
    s_load_dword s77, s[18:19], s42
    s_load_dword s78, s[20:21], s42
    s_setprio 0
    s_add_u32 s64, s38, 0xb10000
    s_addc_u32 s65, s39, 0
    s_mov_b32 s66, 0x8000
    s_mov_b32 s67, 0x20000
    s_mov_b32 s68, s36
    s_mov_b32 s69, s37
    s_mov_b32 s70, 0x100
    s_mov_b32 s71, 0x20000
    s_mov_b32 s48, s38
    s_mov_b32 s49, s39
    s_mov_b32 s50, 0x1000000
    s_mov_b32 s51, 0x20000
    s_lshl_b32 s42, s40, 4
    v_add_u32 v10, s42, v184
    v_mul_u32_u24 v10, 144, v10
    v_lshl_add_u32 v10, v185, 4, v10
    v_add_u32 v10, 61440, v10
    s_waitcnt vmcnt(11)
    ds_write_b128 v10, v[160:163]
    s_waitcnt vmcnt(10)
    ds_write_b128 v10, v[164:167] offset:1152
    s_mov_b32 s46, 0x3f803f80
    v_mov_b32 v12, 0
    v_mov_b32 v13, 0
    v_mov_b32 v14, 0
    v_mov_b32 v15, 0
    s_waitcnt vmcnt(9)
    v_dot2_f32_bf16 v12, v168, s46, v12
    s_waitcnt vmcnt(7)
    v_dot2_f32_bf16 v14, v168, v176, v14
    v_dot2_f32_bf16 v13, v169, s46, v13
    v_dot2_f32_bf16 v15, v169, v177, v15
    v_dot2_f32_bf16 v12, v170, s46, v12
    v_dot2_f32_bf16 v14, v170, v178, v14
    v_dot2_f32_bf16 v13, v171, s46, v13
    v_dot2_f32_bf16 v15, v171, v179, v15
    v_dot2_f32_bf16 v12, v172, s46, v12
    s_waitcnt vmcnt(6)
    v_dot2_f32_bf16 v14, v172, v180, v14
    v_dot2_f32_bf16 v13, v173, s46, v13
    v_dot2_f32_bf16 v15, v173, v181, v15
    v_dot2_f32_bf16 v12, v174, s46, v12
    v_dot2_f32_bf16 v14, v174, v182, v14
    v_dot2_f32_bf16 v13, v175, s46, v13
    v_dot2_f32_bf16 v15, v175, v183, v15
    s_nop 1
    v_add_f32 v12, v12, v13
    v_add_f32 v14, v14, v15
    s_nop 0
    v_add_f32_dpp v12, v12, v12 quad_perm:[1,0,3,2] row_mask:0xf bank_mask:0xf
    s_nop 1
    v_add_f32_dpp v12, v12, v12 quad_perm:[2,3,0,1] row_mask:0xf bank_mask:0xf
    s_nop 1
    v_add_f32_dpp v12, v12, v12 row_half_mirror row_mask:0xf bank_mask:0xf
    s_nop 1
    v_add_f32_dpp v12, v12, v12 row_mirror row_mask:0xf bank_mask:0xf
    v_mov_b32 v16, v12
    s_nop 1
    v_permlane16_swap_b32 v12, v16
    v_add_f32 v12, v12, v16
    v_add_f32_dpp v14, v14, v14 quad_perm:[1,0,3,2] row_mask:0xf bank_mask:0xf
    s_nop 1
    v_add_f32_dpp v14, v14, v14 quad_perm:[2,3,0,1] row_mask:0xf bank_mask:0xf
    s_nop 1
    v_add_f32_dpp v14, v14, v14 row_half_mirror row_mask:0xf bank_mask:0xf
    s_nop 1
    v_add_f32_dpp v14, v14, v14 row_mirror row_mask:0xf bank_mask:0xf
    v_mov_b32 v17, v14
    s_nop 1
    v_permlane16_swap_b32 v14, v17
    v_add_f32 v14, v14, v17
    v_mul_f32 v12, 0x3b000000, v12
    v_mov_b32 v20, 0
    v_mov_b32 v21, 0
    v_mov_b32 v22, 0
    v_mov_b32 v23, 0
    v_lshlrev_b32 v24, 16, v168
    v_and_b32 v25, 0xffff0000, v168
    v_lshlrev_b32 v26, 16, v169
    v_and_b32 v27, 0xffff0000, v169
    v_sub_f32 v24, v24, v12
    v_sub_f32 v25, v25, v12
    v_sub_f32 v26, v26, v12
    v_sub_f32 v27, v27, v12
    v_fmac_f32 v20, v24, v24
    v_fmac_f32 v21, v25, v25
    v_fmac_f32 v22, v26, v26
    v_fmac_f32 v23, v27, v27
    v_lshlrev_b32 v24, 16, v170
    v_and_b32 v25, 0xffff0000, v170
    v_lshlrev_b32 v26, 16, v171
    v_and_b32 v27, 0xffff0000, v171
    v_sub_f32 v24, v24, v12
    v_sub_f32 v25, v25, v12
    v_sub_f32 v26, v26, v12
    v_sub_f32 v27, v27, v12
    v_fmac_f32 v20, v24, v24
    v_fmac_f32 v21, v25, v25
    v_fmac_f32 v22, v26, v26
    v_fmac_f32 v23, v27, v27
    v_lshlrev_b32 v24, 16, v172
    v_and_b32 v25, 0xffff0000, v172
    v_lshlrev_b32 v26, 16, v173
    v_and_b32 v27, 0xffff0000, v173
    v_sub_f32 v24, v24, v12
    v_sub_f32 v25, v25, v12
    v_sub_f32 v26, v26, v12
    v_sub_f32 v27, v27, v12
    v_fmac_f32 v20, v24, v24
    v_fmac_f32 v21, v25, v25
    v_fmac_f32 v22, v26, v26
    v_fmac_f32 v23, v27, v27
    v_lshlrev_b32 v24, 16, v174
    v_and_b32 v25, 0xffff0000, v174
    v_lshlrev_b32 v26, 16, v175
    v_and_b32 v27, 0xffff0000, v175
    v_sub_f32 v24, v24, v12
    v_sub_f32 v25, v25, v12
    v_sub_f32 v26, v26, v12
    v_sub_f32 v27, v27, v12
    v_fmac_f32 v20, v24, v24
    v_fmac_f32 v21, v25, v25
    v_fmac_f32 v22, v26, v26
    v_fmac_f32 v23, v27, v27
    v_add_f32 v20, v20, v21
    v_add_f32 v22, v22, v23
    v_add_f32 v20, v20, v22
    s_nop 1
    v_add_f32_dpp v20, v20, v20 quad_perm:[1,0,3,2] row_mask:0xf bank_mask:0xf
    s_nop 1
    v_add_f32_dpp v20, v20, v20 quad_perm:[2,3,0,1] row_mask:0xf bank_mask:0xf
    s_nop 1
    v_add_f32_dpp v20, v20, v20 row_half_mirror row_mask:0xf bank_mask:0xf
    s_nop 1
    v_add_f32_dpp v20, v20, v20 row_mirror row_mask:0xf bank_mask:0xf
    v_mov_b32 v16, v20
    s_nop 1
    v_permlane16_swap_b32 v20, v16
    v_add_f32 v20, v20, v16
    v_cvt_pk_bf16_f32 v14, v14, v14
    v_lshlrev_b32 v14, 16, v14
    v_mul_f32 v14, 0xbfb8aa3b, v14
    v_exp_f32 v14, v14
    v_mul_f32 v20, 0x3b000000, v20
    v_add_f32 v14, 1.0, v14
    v_rcp_f32 v14, v14
    v_cvt_pk_bf16_f32 v20, v20, v20
    v_lshlrev_b32 v20, 16, v20
    v_add_f32 v20, 0x3727c5ac, v20
    v_cvt_pk_bf16_f32 v14, v14, v14
    v_lshlrev_b32 v14, 16, v14
    v_cvt_pk_bf16_f32 v20, v20, v20
    v_lshlrev_b32 v20, 16, v20
    v_sqrt_f32 v20, v20
    v_cvt_pk_bf16_f32 v12, v12, v12
    v_lshlrev_b32 v12, 16, v12
    v_cvt_pk_bf16_f32 v13, v20, v20
    v_lshlrev_b32 v13, 16, v13
    v_lshlrev_b32 v8, 2, v186
    v_add_u32 v8, 0xb00000, v8
    v_lshlrev_b32 v9, 3, v186
    v_add_u32 v9, 0xb02000, v9
    s_mov_b32 exec_lo, 1
    s_mov_b32 exec_hi, 1
    buffer_store_dword v14, v8, s[48:51], 0 offen sc1
    buffer_store_dwordx2 v[12:13], v9, s[48:51], 0 offen sc1
    s_mov_b64 exec, -1
    s_waitcnt lgkmcnt(0)
    s_barrier
    v_and_b32 v2, 15, v1
    v_lshrrev_b32 v3, 4, v1
    v_lshrrev_b32 v4, 2, v2
    v_lshl_add_u32 v4, v3, 3, v4
    v_mul_u32_u24 v4, 144, v4
    v_and_b32 v5, 3, v2
    v_lshl_add_u32 v4, v5, 3, v4
    s_lshl_b32 s42, s40, 5
    s_add_u32 s42, s42, 61440
    v_add_u32 v4, s42, v4
    ds_read_b64_tr_b16 v[64:65], v4 offset:0
    ds_read_b64_tr_b16 v[66:67], v4 offset:576
    ds_read_b64_tr_b16 v[68:69], v4 offset:4608
    ds_read_b64_tr_b16 v[70:71], v4 offset:5184
    s_lshl_b32 s42, s76, 6
    s_lshl_b32 s43, s40, 4
    s_add_u32 s42, s42, s43
    v_add_u32 v5, s42, v2
    v_lshlrev_b32 v5, 12, v5
    v_lshl_add_u32 v5, v3, 4, v5
    s_lshl_b32 s42, s75, 7
    v_add_u32 v5, s42, v5
    s_waitcnt lgkmcnt(2)
    buffer_store_dwordx4 v[64:67], v5, s[48:51], 0 offen offset:0 sc1
    s_waitcnt lgkmcnt(0)
    buffer_store_dwordx4 v[68:71], v5, s[48:51], 0 offen offset:64 sc1
    s_waitcnt lgkmcnt(0)
    s_lshl_b32 s42, s79, 4
    s_lshr_b32 s77, s77, s42
    s_lshl_b32 s77, s77, 16
    s_lshr_b32 s78, s78, s42
    s_lshl_b32 s78, s78, 16
    v_mov_b32 v2, s77
    v_mul_f32 v3, 0x3fb8aa3b, v2
    s_mov_b32 s42, 0x3fb8aa3b
    v_fma_f32 v4, v2, s42, -v3
    v_fmac_f32 v4, 0x32a57060, v2
    v_exp_f32 v3, v3
    v_mul_f32 v4, 0x3f317218, v4
    v_fmac_f32 v3, v3, v4
    v_cvt_pk_bf16_f32 v2, v3, v3
    v_lshlrev_b32 v2, 16, v2
    s_waitcnt vmcnt(9)
    v_lshlrev_b32 v40, 16, v40
    s_waitcnt vmcnt(8)
    v_lshlrev_b32 v41, 16, v41
    s_waitcnt vmcnt(7)
    v_lshlrev_b32 v42, 16, v42
    s_waitcnt vmcnt(6)
    v_lshlrev_b32 v43, 16, v43
    s_waitcnt vmcnt(5)
    v_lshlrev_b32 v44, 16, v44
    s_waitcnt vmcnt(4)
    v_lshlrev_b32 v45, 16, v45
    v_mul_f32 v46, v2, v40
    v_mul_f32 v47, v2, v41
    v_mul_f32 v46, 0x3fb8aa3b, v46
    v_mul_f32 v47, 0x3e22f983, v47
    v_mul_f32 v42, v2, v42
    v_mul_f32 v43, v2, v43
    v_mul_f32 v48, v44, v42
    v_mul_f32 v49, v44, v43
    v_mul_f32 v3, v45, v43
    v_fmac_f32 v49, v45, v42
    v_sub_f32 v48, v48, v3
    v_mul_f32 v4, 0x3f800000, v46
    v_mul_f32 v5, 0x3f800000, v47
    v_exp_f32 v4, v4
    v_fract_f32 v5, v5
    v_cos_f32 v50, v5
    v_sin_f32 v51, v5
    v_mul_f32 v50, v50, v4
    v_mul_f32 v51, v51, v4
    v_mul_f32 v6, 0x41000000, v46
    v_mul_f32 v7, 0x41000000, v47
    v_exp_f32 v6, v6
    v_fract_f32 v7, v7
    v_cos_f32 v53, v7
    v_sin_f32 v54, v7
    v_mul_f32 v53, v53, v6
    v_mul_f32 v54, v54, v6
    v_mul_f32 v8, 0x43800000, v46
    v_mul_f32 v9, 0x43800000, v47
    v_exp_f32 v8, v8
    v_fract_f32 v9, v9
    v_cos_f32 v56, v9
    v_sin_f32 v57, v9
    v_mul_f32 v56, v56, v8
    v_mul_f32 v57, v57, v8
    v_sub_f32 v52, 0, v51
    v_sub_f32 v55, 0, v54
    v_sub_f32 v58, 0, v57
    v_mul_f32 v59, v50, v50
    v_mul_f32 v60, v50, v51
    v_fmac_f32 v59, v51, v52
    v_fmac_f32 v60, v51, v50
    v_sub_f32 v61, 0, v60
    v_mul_f32 v62, v59, v59
    v_mul_f32 v63, v59, v60
    v_fmac_f32 v62, v60, v61
    v_fmac_f32 v63, v60, v59
    v_sub_f32 v64, 0, v63
    s_mul_i32 s42, s40, 15360
    v_lshlrev_b32 v39, 2, v1
    v_add_u32 v39, s42, v39
    s_waitcnt vmcnt(0)
    s_cmp_eq_u32 s40, 0
    s_cbranch_scc0 L_ssm_rdyw_skip
    v_mov_b32 v33, 0
    s_mov_b32 s45, 200000
L_ssm_rdy_spin:
    s_mov_b64 exec, 0x1
    buffer_load_dword v34, v33, s[68:71], 0 offen offset:0 sc1
    s_waitcnt vmcnt(0)
    v_cmp_eq_u32 vcc, 1, v34
    s_mov_b64 s[46:47], exec
    s_mov_b64 exec, -1
    s_nop 1
    s_cmp_eq_u64 vcc, s[46:47]
    s_cbranch_scc1 L_ssm_rdy_done
    s_sleep 3
    s_sub_u32 s45, s45, 1
    s_cmp_lg_u32 s45, 0
    s_cbranch_scc1 L_ssm_rdy_spin
L_ssm_rdy_done:
L_ssm_rdyw_skip:
    s_barrier
    s_cmp_eq_u32 s40, 0
    s_cbranch_scc0 L_ssm_pub_skip
    s_lshl_b32 s42, s41, 5
    s_add_u32 s42, s42, 0
    v_mov_b32 v35, s42
    v_mov_b32 v36, 1
    s_mov_b64 exec, 1
    buffer_store_dword v36, v35, s[64:67], 0 offen offset:0 sc1
    s_mov_b64 exec, -1
L_ssm_pub_skip:
    s_setprio 0
    v_mov_b32 v66, 1.0
    v_mov_b32 v67, 0
    v_cvt_pk_bf16_f32 v70, v66, v67
    v_cvt_pk_bf16_f32 v71, v53, v54
    v_add_u32 v78, 6528, v39
    ds_write2_b32 v78, v70, v71 offset0:0 offset1:68
    v_mul_f32 v66, v53, v53
    v_mul_f32 v67, v53, v54
    v_fmac_f32 v66, v54, v55
    v_fmac_f32 v67, v54, v53
    v_cvt_pk_bf16_f32 v72, v66, v67
    v_mul_f32 v68, v66, v53
    v_mul_f32 v69, v66, v54
    v_fmac_f32 v68, v67, v55
    v_fmac_f32 v69, v67, v53
    v_cvt_pk_bf16_f32 v73, v68, v69
    ds_write2_b32 v78, v72, v73 offset0:136 offset1:204
    v_mul_f32 v66, v68, v53
    v_mul_f32 v67, v68, v54
    v_fmac_f32 v66, v69, v55
    v_fmac_f32 v67, v69, v53
    v_cvt_pk_bf16_f32 v70, v66, v67
    v_mul_f32 v68, v66, v53
    v_mul_f32 v69, v66, v54
    v_fmac_f32 v68, v67, v55
    v_fmac_f32 v69, v67, v53
    v_cvt_pk_bf16_f32 v71, v68, v69
    v_add_u32 v78, 7616, v39
    ds_write2_b32 v78, v70, v71 offset0:0 offset1:68
    v_mul_f32 v66, v68, v53
    v_mul_f32 v67, v68, v54
    v_fmac_f32 v66, v69, v55
    v_fmac_f32 v67, v69, v53
    v_cvt_pk_bf16_f32 v72, v66, v67
    v_mul_f32 v68, v66, v53
    v_mul_f32 v69, v66, v54
    v_fmac_f32 v68, v67, v55
    v_fmac_f32 v69, v67, v53
    v_cvt_pk_bf16_f32 v73, v68, v69
    ds_write2_b32 v78, v72, v73 offset0:136 offset1:204
    v_mul_f32 v66, v68, v53
    v_mul_f32 v67, v68, v54
    v_fmac_f32 v66, v69, v55
    v_fmac_f32 v67, v69, v53
    v_cvt_pk_bf16_f32 v70, v66, v67
    v_mul_f32 v68, v66, v53
    v_mul_f32 v69, v66, v54
    v_fmac_f32 v68, v67, v55
    v_fmac_f32 v69, v67, v53
    v_cvt_pk_bf16_f32 v71, v68, v69
    v_add_u32 v78, 8704, v39
    ds_write2_b32 v78, v70, v71 offset0:0 offset1:68
    v_mul_f32 v66, v68, v53
    v_mul_f32 v67, v68, v54
    v_fmac_f32 v66, v69, v55
    v_fmac_f32 v67, v69, v53
    v_cvt_pk_bf16_f32 v72, v66, v67
    v_mul_f32 v68, v66, v53
    v_mul_f32 v69, v66, v54
    v_fmac_f32 v68, v67, v55
    v_fmac_f32 v69, v67, v53
    v_cvt_pk_bf16_f32 v73, v68, v69
    ds_write2_b32 v78, v72, v73 offset0:136 offset1:204
    v_mul_f32 v66, v68, v53
    v_mul_f32 v67, v68, v54
    v_fmac_f32 v66, v69, v55
    v_fmac_f32 v67, v69, v53
    v_cvt_pk_bf16_f32 v70, v66, v67
    v_mul_f32 v68, v66, v53
    v_mul_f32 v69, v66, v54
    v_fmac_f32 v68, v67, v55
    v_fmac_f32 v69, v67, v53
    v_cvt_pk_bf16_f32 v71, v68, v69
    v_add_u32 v78, 9792, v39
    ds_write2_b32 v78, v70, v71 offset0:0 offset1:68
    v_mul_f32 v66, v68, v53
    v_mul_f32 v67, v68, v54
    v_fmac_f32 v66, v69, v55
    v_fmac_f32 v67, v69, v53
    v_cvt_pk_bf16_f32 v72, v66, v67
    v_mul_f32 v68, v66, v53
    v_mul_f32 v69, v66, v54
    v_fmac_f32 v68, v67, v55
    v_fmac_f32 v69, v67, v53
    v_cvt_pk_bf16_f32 v73, v68, v69
    ds_write2_b32 v78, v72, v73 offset0:136 offset1:204
    v_mul_f32 v66, v68, v53
    v_mul_f32 v67, v68, v54
    v_fmac_f32 v66, v69, v55
    v_fmac_f32 v67, v69, v53
    v_cvt_pk_bf16_f32 v70, v66, v67
    v_mul_f32 v68, v66, v53
    v_mul_f32 v69, v66, v54
    v_fmac_f32 v68, v67, v55
    v_fmac_f32 v69, v67, v53
    v_cvt_pk_bf16_f32 v71, v68, v69
    v_add_u32 v78, 10880, v39
    ds_write2_b32 v78, v70, v71 offset0:0 offset1:68
    v_mul_f32 v66, v68, v53
    v_mul_f32 v67, v68, v54
    v_fmac_f32 v66, v69, v55
    v_fmac_f32 v67, v69, v53
    v_cvt_pk_bf16_f32 v72, v66, v67
    v_mul_f32 v68, v66, v53
    v_mul_f32 v69, v66, v54
    v_fmac_f32 v68, v67, v55
    v_fmac_f32 v69, v67, v53
    v_cvt_pk_bf16_f32 v73, v68, v69
    ds_write2_b32 v78, v72, v73 offset0:136 offset1:204
    v_mul_f32 v66, v68, v53
    v_mul_f32 v67, v68, v54
    v_fmac_f32 v66, v69, v55
    v_fmac_f32 v67, v69, v53
    v_cvt_pk_bf16_f32 v70, v66, v67
    v_mul_f32 v68, v66, v53
    v_mul_f32 v69, v66, v54
    v_fmac_f32 v68, v67, v55
    v_fmac_f32 v69, v67, v53
    v_cvt_pk_bf16_f32 v71, v68, v69
    v_add_u32 v78, 11968, v39
    ds_write2_b32 v78, v70, v71 offset0:0 offset1:68
    v_mul_f32 v66, v68, v53
    v_mul_f32 v67, v68, v54
    v_fmac_f32 v66, v69, v55
    v_fmac_f32 v67, v69, v53
    v_cvt_pk_bf16_f32 v72, v66, v67
    v_mul_f32 v68, v66, v53
    v_mul_f32 v69, v66, v54
    v_fmac_f32 v68, v67, v55
    v_fmac_f32 v69, v67, v53
    v_cvt_pk_bf16_f32 v73, v68, v69
    ds_write2_b32 v78, v72, v73 offset0:136 offset1:204
    v_mul_f32 v66, v68, v53
    v_mul_f32 v67, v68, v54
    v_fmac_f32 v66, v69, v55
    v_fmac_f32 v67, v69, v53
    v_cvt_pk_bf16_f32 v70, v66, v67
    v_mul_f32 v68, v66, v53
    v_mul_f32 v69, v66, v54
    v_fmac_f32 v68, v67, v55
    v_fmac_f32 v69, v67, v53
    v_cvt_pk_bf16_f32 v71, v68, v69
    v_add_u32 v78, 13056, v39
    ds_write2_b32 v78, v70, v71 offset0:0 offset1:68
    v_mul_f32 v66, v68, v53
    v_mul_f32 v67, v68, v54
    v_fmac_f32 v66, v69, v55
    v_fmac_f32 v67, v69, v53
    v_cvt_pk_bf16_f32 v72, v66, v67
    v_mul_f32 v68, v66, v53
    v_mul_f32 v69, v66, v54
    v_fmac_f32 v68, v67, v55
    v_fmac_f32 v69, v67, v53
    v_cvt_pk_bf16_f32 v73, v68, v69
    ds_write2_b32 v78, v72, v73 offset0:136 offset1:204
    v_mul_f32 v66, v68, v53
    v_mul_f32 v67, v68, v54
    v_fmac_f32 v66, v69, v55
    v_fmac_f32 v67, v69, v53
    v_cvt_pk_bf16_f32 v70, v66, v67
    v_mul_f32 v68, v66, v53
    v_mul_f32 v69, v66, v54
    v_fmac_f32 v68, v67, v55
    v_fmac_f32 v69, v67, v53
    v_cvt_pk_bf16_f32 v71, v68, v69
    v_add_u32 v78, 14144, v39
    ds_write2_b32 v78, v70, v71 offset0:0 offset1:68
    v_mul_f32 v66, v68, v53
    v_mul_f32 v67, v68, v54
    v_fmac_f32 v66, v69, v55
    v_fmac_f32 v67, v69, v53
    v_cvt_pk_bf16_f32 v72, v66, v67
    v_mul_f32 v68, v66, v53
    v_mul_f32 v69, v66, v54
    v_fmac_f32 v68, v67, v55
    v_fmac_f32 v69, v67, v53
    v_cvt_pk_bf16_f32 v73, v68, v69
    ds_write2_b32 v78, v72, v73 offset0:136 offset1:204
    v_cvt_pk_bf16_f32 v70, v48, -v49
    v_mul_f32 v68, v48, v50
    v_mul_f32 v69, v48, v51
    v_fmac_f32 v68, v49, v52
    v_fmac_f32 v69, v49, v50
    v_cvt_pk_bf16_f32 v71, v68, -v69
    v_add_u32 v78, 0, v39
    ds_write2_b32 v78, v70, v71 offset0:0 offset1:68
    v_mul_f32 v66, v68, v50
    v_mul_f32 v67, v68, v51
    v_fmac_f32 v66, v69, v52
    v_fmac_f32 v67, v69, v50
    v_cvt_pk_bf16_f32 v72, v66, -v67
    v_mul_f32 v68, v66, v50
    v_mul_f32 v69, v66, v51
    v_fmac_f32 v68, v67, v52
    v_fmac_f32 v69, v67, v50
    v_cvt_pk_bf16_f32 v73, v68, -v69
    ds_write2_b32 v78, v72, v73 offset0:136 offset1:204
    v_mul_f32 v66, v68, v50
    v_mul_f32 v67, v68, v51
    v_fmac_f32 v66, v69, v52
    v_fmac_f32 v67, v69, v50
    v_cvt_pk_bf16_f32 v70, v66, -v67
    v_mul_f32 v68, v66, v50
    v_mul_f32 v69, v66, v51
    v_fmac_f32 v68, v67, v52
    v_fmac_f32 v69, v67, v50
    v_cvt_pk_bf16_f32 v71, v68, -v69
    v_add_u32 v78, 1088, v39
    ds_write2_b32 v78, v70, v71 offset0:0 offset1:68
    v_mul_f32 v66, v68, v50
    v_mul_f32 v67, v68, v51
    v_fmac_f32 v66, v69, v52
    v_fmac_f32 v67, v69, v50
    v_cvt_pk_bf16_f32 v72, v66, -v67
    v_mul_f32 v68, v66, v50
    v_mul_f32 v69, v66, v51
    v_fmac_f32 v68, v67, v52
    v_fmac_f32 v69, v67, v50
    v_cvt_pk_bf16_f32 v73, v68, -v69
    ds_write2_b32 v78, v72, v73 offset0:136 offset1:204
    v_mul_f32 v76, v48, v56
    v_mul_f32 v77, v48, v57
    v_fmac_f32 v76, v49, v58
    v_fmac_f32 v77, v49, v56
    v_cvt_pk_bf16_f32 v70, v76, -v77
    v_mul_f32 v68, v76, v59
    v_mul_f32 v69, v76, v60
    v_fmac_f32 v68, v77, v61
    v_fmac_f32 v69, v77, v59
    v_cvt_pk_bf16_f32 v71, v68, -v69
    v_add_u32 v78, 2176, v39
    ds_write2_b32 v78, v70, v71 offset0:0 offset1:68
    v_mul_f32 v66, v68, v59
    v_mul_f32 v67, v68, v60
    v_fmac_f32 v66, v69, v61
    v_fmac_f32 v67, v69, v59
    v_cvt_pk_bf16_f32 v72, v66, -v67
    v_mul_f32 v68, v66, v59
    v_mul_f32 v69, v66, v60
    v_fmac_f32 v68, v67, v61
    v_fmac_f32 v69, v67, v59
    v_cvt_pk_bf16_f32 v73, v68, -v69
    ds_write2_b32 v78, v72, v73 offset0:136 offset1:204
    v_mul_f32 v74, v76, v56
    v_mul_f32 v75, v76, v57
    v_fmac_f32 v74, v77, v58
    v_fmac_f32 v75, v77, v56
    v_cvt_pk_bf16_f32 v70, v74, -v75
    v_mul_f32 v66, v74, v62
    v_mul_f32 v67, v74, v63
    v_fmac_f32 v66, v75, v64
    v_fmac_f32 v67, v75, v62
    v_cvt_pk_bf16_f32 v71, v66, -v67
    v_add_u32 v78, 3264, v39
    ds_write2_b32 v78, v70, v71 offset0:0 offset1:68
    v_mul_f32 v76, v74, v56
    v_mul_f32 v77, v74, v57
    v_fmac_f32 v76, v75, v58
    v_fmac_f32 v77, v75, v56
    v_cvt_pk_bf16_f32 v72, v76, -v77
    v_mul_f32 v66, v76, v62
    v_mul_f32 v67, v76, v63
    v_fmac_f32 v66, v77, v64
    v_fmac_f32 v67, v77, v62
    v_cvt_pk_bf16_f32 v73, v66, -v67
    ds_write2_b32 v78, v72, v73 offset0:136 offset1:204
    v_mul_f32 v74, v76, v56
    v_mul_f32 v75, v76, v57
    v_fmac_f32 v74, v77, v58
    v_fmac_f32 v75, v77, v56
    v_cvt_pk_bf16_f32 v70, v74, -v75
    v_mul_f32 v76, v74, v56
    v_mul_f32 v77, v74, v57
    v_fmac_f32 v76, v75, v58
    v_fmac_f32 v77, v75, v56
    v_cvt_pk_bf16_f32 v71, v76, -v77
    v_add_u32 v78, 4352, v39
    ds_write2_b32 v78, v70, v71 offset0:0 offset1:68
    v_mul_f32 v74, v76, v56
    v_mul_f32 v75, v76, v57
    v_fmac_f32 v74, v77, v58
    v_fmac_f32 v75, v77, v56
    v_cvt_pk_bf16_f32 v72, v74, -v75
    v_mul_f32 v76, v74, v56
    v_mul_f32 v77, v74, v57
    v_fmac_f32 v76, v75, v58
    v_fmac_f32 v77, v75, v56
    v_cvt_pk_bf16_f32 v73, v76, -v77
    ds_write2_b32 v78, v72, v73 offset0:136 offset1:204
    v_mul_f32 v74, v76, v56
    v_mul_f32 v75, v76, v57
    v_fmac_f32 v74, v77, v58
    v_fmac_f32 v75, v77, v56
    v_cvt_pk_bf16_f32 v70, v74, -v75
    ds_write_b32 v39, v70 offset:5440
    s_lshr_b32 s42, s41, 5
    v_and_b32 v35, 7, v1
    v_lshrrev_b32 v36, 3, v1
    v_lshlrev_b32 v36, 3, v36
    v_add_u32 v36, s42, v36
    v_lshl_add_u32 v35, v36, 3, v35
    v_lshlrev_b32 v35, 5, v35
    s_lshl_b32 s42, s81, 12
    s_add_u32 s52, s38, s42
    s_addc_u32 s53, s39, 0
    s_mov_b32 s54, 0x1000
    s_mov_b32 s55, 0x20000
    s_lshl_b32 s42, s80, 11
    v_lshlrev_b32 v29, 4, v1
    v_add_u32 v29, s42, v29
    v_subrev_u32 v30, 32, v29
    v_add_u32 v31, 1024, v30
    v_add_u32 v32, 2048, v30
    s_mov_b32 exec_lo, 0xffffffff
    s_mov_b32 exec_hi, 0x0
    buffer_load_dword v34, v35, s[64:67], 0 offen offset:0 sc1
    s_mov_b64 exec, -1
    v_and_b32 v2, 31, v1
    v_lshrrev_b32 v3, 5, v1
    v_mul_u32_u24 v4, 272, v2
    v_lshl_add_u32 v4, v3, 4, v4
    s_mul_i32 s42, s40, 15360
    v_add_u32 v4, s42, v4
    ds_read_b128 v[128:131], v4 offset:0
    ds_read_b128 v[132:135], v4 offset:6528
    ds_read_b128 v[136:139], v4 offset:32
    ds_read_b128 v[140:143], v4 offset:6560
    ds_read_b128 v[144:147], v4 offset:64
    ds_read_b128 v[148:151], v4 offset:6592
    ds_read_b128 v[152:155], v4 offset:96
    ds_read_b128 v[156:159], v4 offset:6624
    ds_read_b128 v[160:163], v4 offset:128
    ds_read_b128 v[164:167], v4 offset:6656
    ds_read_b128 v[168:171], v4 offset:160
    ds_read_b128 v[172:175], v4 offset:6688
    ds_read_b128 v[176:179], v4 offset:192
    ds_read_b128 v[180:183], v4 offset:6720
    ds_read_b128 v[184:187], v4 offset:224
    ds_read_b128 v[188:191], v4 offset:6752
    s_waitcnt lgkmcnt(14)
    v_mfma_f32_32x32x16_bf16 v[96:111], v[128:131], v[132:135], 0
    s_waitcnt lgkmcnt(12)
    v_mfma_f32_32x32x16_bf16 v[96:111], v[136:139], v[140:143], v[96:111]
    s_waitcnt lgkmcnt(10)
    v_mfma_f32_32x32x16_bf16 v[96:111], v[144:147], v[148:151], v[96:111]
    s_waitcnt lgkmcnt(8)
    v_mfma_f32_32x32x16_bf16 v[96:111], v[152:155], v[156:159], v[96:111]
    s_waitcnt lgkmcnt(6)
    v_mfma_f32_32x32x16_bf16 v[96:111], v[160:163], v[164:167], v[96:111]
    s_waitcnt lgkmcnt(4)
    v_mfma_f32_32x32x16_bf16 v[96:111], v[168:171], v[172:175], v[96:111]
    s_waitcnt lgkmcnt(2)
    v_mfma_f32_32x32x16_bf16 v[96:111], v[176:179], v[180:183], v[96:111]
    s_waitcnt lgkmcnt(0)
    v_mfma_f32_32x32x16_bf16 v[96:111], v[184:187], v[188:191], v[96:111]
    s_waitcnt vmcnt(0)
    s_mov_b32 exec_lo, 0xffffffff
    s_mov_b32 exec_hi, 0x0
    v_cmp_eq_u32 vcc, 1, v34
    s_mov_b64 s[46:47], exec
    s_mov_b64 exec, -1
    s_nop 1
    s_cmp_eq_u64 vcc, s[46:47]
    s_cselect_b32 s82, 1, 0
    s_cbranch_scc0 L_ssm_noearly
    buffer_load_dwordx4 v[160:163], v30, s[52:55], 0 offen sc1
    buffer_load_dwordx2 v[164:165], v30, s[52:55], 0 offen offset:16 sc1
    buffer_load_dwordx4 v[168:171], v31, s[52:55], 0 offen sc1
    buffer_load_dwordx2 v[172:173], v31, s[52:55], 0 offen offset:16 sc1
    buffer_load_dwordx4 v[176:179], v32, s[52:55], 0 offen sc1
    buffer_load_dwordx2 v[180:181], v32, s[52:55], 0 offen offset:16 sc1
L_ssm_noearly:
    s_lshl_b32 s42, s80, 12
    v_lshlrev_b32 v5, 5, v1
    v_add_u32 v5, s42, v5
    s_getpc_b64 s[44:45]
L_kg_pc:
    s_add_u32 s44, s44, KIDX_TABLE-L_kg_pc
    s_addc_u32 s45, s45, 0
    global_load_dwordx4 v[200:203], v5, s[44:45] offset:0
    global_load_dwordx4 v[204:207], v5, s[44:45] offset:16
    global_load_dwordx4 v[208:211], v5, s[44:45] offset:2048
    global_load_dwordx4 v[212:215], v5, s[44:45] offset:2064
    s_mul_i32 s42, s79, 3072
    s_add_u32 s42, s42, 73664
    v_lshlrev_b32 v6, 4, v1
    v_add_u32 v6, s42, v6
    s_cmp_eq_u32 s80, 0
    s_cbranch_scc1 L_kg_k1
    ds_write_b128 v6, v[96:99] offset:0
    ds_write_b128 v6, v[100:103] offset:1024
    ds_write_b128 v6, v[104:107] offset:2048
L_kg_k1:
    s_nop 11
    s_waitcnt lgkmcnt(0)
    s_barrier
    s_cmp_eq_u32 s80, 0
    s_cbranch_scc0 L_kg_k2
    ds_read_b128 v[128:131], v6 offset:0
    ds_read_b128 v[132:135], v6 offset:1024
    ds_read_b128 v[136:139], v6 offset:2048
    s_waitcnt lgkmcnt(2)
    v_add_f32 v96, v96, v128
    v_add_f32 v97, v97, v129
    v_add_f32 v98, v98, v130
    v_add_f32 v99, v99, v131
    s_waitcnt lgkmcnt(1)
    v_add_f32 v100, v100, v132
    v_add_f32 v101, v101, v133
    v_add_f32 v102, v102, v134
    v_add_f32 v103, v103, v135
    s_waitcnt lgkmcnt(0)
    v_add_f32 v104, v104, v136
    v_add_f32 v105, v105, v137
    v_add_f32 v106, v106, v138
    v_add_f32 v107, v107, v139
    v_cvt_pk_bf16_f32 v128, v96, v97
    v_cvt_pk_bf16_f32 v129, v98, v99
    v_cvt_pk_bf16_f32 v130, v100, v101
    v_cvt_pk_bf16_f32 v131, v102, v103
    v_cvt_pk_bf16_f32 v132, v104, v105
    v_cvt_pk_bf16_f32 v133, v106, v107
    s_mul_i32 s42, s79, 1536
    s_add_u32 s42, s42, 70592
    v_lshlrev_b32 v7, 4, v2
    v_lshl_add_u32 v7, v3, 3, v7
    v_add_u32 v7, s42, v7
    ds_write_b64 v7, v[128:129]
    v_cmp_eq_u32 vcc, 0, v3
    v_lshlrev_b32 v8, 3, v2
    v_add_u32 v8, 512, v8
    v_lshlrev_b32 v9, 2, v2
    v_add_u32 v10, 768, v9
    v_cndmask_b32 v10, v10, v8, vcc
    v_add_u32 v8, 4, v8
    v_add_u32 v9, 896, v9
    v_cndmask_b32 v9, v9, v8, vcc
    v_add_u32 v10, s42, v10
    v_add_u32 v9, s42, v9
    ds_write_b32 v10, v130
    ds_write_b32 v9, v131
    v_lshlrev_b32 v8, 1, v2
    v_lshl_add_u32 v8, v3, 8, v8
    v_add_u32 v8, s42, v8
    ds_write_b16 v8, v132 offset:1024
    ds_write_b16_d16_hi v8, v132 offset:1088
    ds_write_b16 v8, v133 offset:1152
    ds_write_b16_d16_hi v8, v133 offset:1216
L_kg_k2:
    s_waitcnt lgkmcnt(0)
    s_barrier
    s_mul_i32 s42, s79, 1536
    s_add_u32 s42, s42, 70592
    s_waitcnt vmcnt(3)
    v_add_u32 v200, s42, v200
    v_add_u32 v201, s42, v201
    v_add_u32 v202, s42, v202
    v_add_u32 v203, s42, v203
    s_waitcnt vmcnt(2)
    v_add_u32 v204, s42, v204
    v_add_u32 v205, s42, v205
    v_add_u32 v206, s42, v206
    v_add_u32 v207, s42, v207
    s_waitcnt vmcnt(1)
    v_add_u32 v208, s42, v208
    v_add_u32 v209, s42, v209
    v_add_u32 v210, s42, v210
    v_add_u32 v211, s42, v211
    s_waitcnt vmcnt(0)
    v_add_u32 v212, s42, v212
    v_add_u32 v213, s42, v213
    v_add_u32 v214, s42, v214
    v_add_u32 v215, s42, v215
    ds_read_u16 v216, v200
    ds_read_u16 v217, v201
    ds_read_u16 v218, v202
    ds_read_u16 v219, v203
    ds_read_u16 v220, v204
    ds_read_u16 v221, v205
    ds_read_u16 v222, v206
    ds_read_u16 v223, v207
    ds_read_u16 v224, v208
    ds_read_u16 v225, v209
    ds_read_u16 v226, v210
    ds_read_u16 v227, v211
    ds_read_u16 v228, v212
    ds_read_u16 v229, v213
    ds_read_u16 v230, v214
    ds_read_u16 v231, v215
    s_waitcnt lgkmcnt(14)
    v_lshl_or_b32 v128, v217, 16, v216
    s_waitcnt lgkmcnt(12)
    v_lshl_or_b32 v129, v219, 16, v218
    s_waitcnt lgkmcnt(10)
    v_lshl_or_b32 v130, v221, 16, v220
    s_waitcnt lgkmcnt(8)
    v_lshl_or_b32 v131, v223, 16, v222
    s_waitcnt lgkmcnt(6)
    v_lshl_or_b32 v132, v225, 16, v224
    s_waitcnt lgkmcnt(4)
    v_lshl_or_b32 v133, v227, 16, v226
    s_waitcnt lgkmcnt(2)
    v_lshl_or_b32 v134, v229, 16, v228
    s_waitcnt lgkmcnt(0)
    v_lshl_or_b32 v135, v231, 16, v230
    s_mul_i32 s42, s79, 4576
    s_add_u32 s42, s42, 61440
    s_lshl_b32 s43, s80, 11
    s_sub_u32 s43, s42, s43
    s_add_u32 s43, s43, 4080
    v_lshlrev_b32 v7, 4, v1
    v_sub_u32 v7, s43, v7
    ds_write_b128 v7, v[128:131]
    v_subrev_u32 v8, 1024, v7
    ds_write_b128 v8, v[132:135]
    v_mov_b32 v136, 0
    v_mov_b32 v137, 0
    v_mov_b32 v138, 0
    v_mov_b32 v139, 0
    v_lshlrev_b32 v8, 4, v1
    s_add_u32 s42, s42, 4096
    v_add_u32 v8, s42, v8
    s_mov_b64 exec, 0x3fffffff
    ds_write_b128 v8, v[136:139]
    s_mov_b64 exec, -1
    s_cmp_eq_u32 s82, 1
    s_cbranch_scc1 L_ssm_have
    s_mov_b32 s45, 200000
L_ssm_ut_spin:
    s_mov_b32 exec_lo, 0xffffffff
    s_mov_b32 exec_hi, 0x0
    buffer_load_dword v34, v35, s[64:67], 0 offen offset:0 sc1
    s_waitcnt vmcnt(0)
    v_cmp_eq_u32 vcc, 1, v34
    s_mov_b64 s[46:47], exec
    s_mov_b64 exec, -1
    s_nop 1
    s_cmp_eq_u64 vcc, s[46:47]
    s_cbranch_scc1 L_ssm_ut_done
    s_sleep 2
    s_sub_u32 s45, s45, 1
    s_cmp_lg_u32 s45, 0
    s_cbranch_scc1 L_ssm_ut_spin
L_ssm_ut_done:
    buffer_load_dwordx4 v[160:163], v30, s[52:55], 0 offen sc1
    buffer_load_dwordx2 v[164:165], v30, s[52:55], 0 offen offset:16 sc1
    buffer_load_dwordx4 v[168:171], v31, s[52:55], 0 offen sc1
    buffer_load_dwordx2 v[172:173], v31, s[52:55], 0 offen offset:16 sc1
    buffer_load_dwordx4 v[176:179], v32, s[52:55], 0 offen sc1
    buffer_load_dwordx2 v[180:181], v32, s[52:55], 0 offen offset:16 sc1
L_ssm_have:
    s_waitcnt vmcnt(0) lgkmcnt(0)
    s_barrier
    s_mul_i32 s42, s79, 16640
    s_add_u32 s42, s42, 0
    v_add_u32 v2, s42, v29
    v_alignbit_b32 v184, v161, v160, 16
    v_alignbit_b32 v185, v162, v161, 16
    v_alignbit_b32 v186, v163, v162, 16
    v_alignbit_b32 v187, v164, v163, 16
    v_mov_b32 v188, v161
    v_mov_b32 v189, v162
    v_mov_b32 v190, v163
    v_mov_b32 v191, v164
    v_alignbit_b32 v192, v162, v161, 16
    v_alignbit_b32 v193, v163, v162, 16
    v_alignbit_b32 v194, v164, v163, 16
    v_alignbit_b32 v195, v165, v164, 16
    ds_write_b128 v2, v[160:163] offset:0
    ds_write_b128 v2, v[184:187] offset:4160
    ds_write_b128 v2, v[188:191] offset:8320
    ds_write_b128 v2, v[192:195] offset:12480
    v_alignbit_b32 v196, v169, v168, 16
    v_alignbit_b32 v197, v170, v169, 16
    v_alignbit_b32 v198, v171, v170, 16
    v_alignbit_b32 v199, v172, v171, 16
    v_mov_b32 v200, v169
    v_mov_b32 v201, v170
    v_mov_b32 v202, v171
    v_mov_b32 v203, v172
    v_alignbit_b32 v204, v170, v169, 16
    v_alignbit_b32 v205, v171, v170, 16
    v_alignbit_b32 v206, v172, v171, 16
    v_alignbit_b32 v207, v173, v172, 16
    ds_write_b128 v2, v[168:171] offset:1024
    ds_write_b128 v2, v[196:199] offset:5184
    ds_write_b128 v2, v[200:203] offset:9344
    ds_write_b128 v2, v[204:207] offset:13504
    s_cmp_eq_u32 s80, 1
    s_cselect_b64 exec, 3, 0
    v_alignbit_b32 v184, v177, v176, 16
    v_alignbit_b32 v185, v178, v177, 16
    v_alignbit_b32 v186, v179, v178, 16
    v_alignbit_b32 v187, v180, v179, 16
    v_mov_b32 v188, v177
    v_mov_b32 v189, v178
    v_mov_b32 v190, v179
    v_mov_b32 v191, v180
    v_alignbit_b32 v192, v178, v177, 16
    v_alignbit_b32 v193, v179, v178, 16
    v_alignbit_b32 v194, v180, v179, 16
    v_alignbit_b32 v195, v181, v180, 16
    ds_write_b128 v2, v[176:179] offset:2048
    ds_write_b128 v2, v[184:187] offset:6208
    ds_write_b128 v2, v[188:191] offset:10368
    ds_write_b128 v2, v[192:195] offset:14528
    s_mov_b64 exec, -1
    s_waitcnt lgkmcnt(0)
    s_barrier
    s_setprio 3
    v_and_b32 v4, 15, v1
    v_lshrrev_b32 v5, 4, v1
    v_lshlrev_b32 v6, 1, v4
    v_sub_u32 v6, v5, v6
    v_lshlrev_b32 v6, 4, v6
    s_mul_i32 s42, s79, 4576
    s_add_u32 s42, s42, 62176
    s_lshl_b32 s43, s80, 8
    s_sub_u32 s42, s42, s43
    v_add_u32 v2, s42, v6
    v_add_u32 v6, 1, v4
    v_and_b32 v7, 3, v6
    v_sub_u32 v6, v6, v7
    v_lshlrev_b32 v6, 1, v6
    v_mul_u32_u24 v7, 4160, v7
    v_add_u32 v6, v6, v7
    v_lshl_add_u32 v6, v5, 4, v6
    s_mul_i32 s42, s79, 16640
    s_add_u32 s42, s42, 256
    s_sub_u32 s42, s42, s43
    v_add_u32 v3, s42, v6
    ds_read_b128 v[96:99], v2 offset:3776
    ds_read_b64 v[64:65], v3 offset:192
    ds_read_b64 v[66:67], v3 offset:200
    ds_read_b128 v[100:103], v2 offset:3264
    ds_read_b64 v[68:69], v3 offset:704
    ds_read_b64 v[70:71], v3 offset:712
    ds_read_b128 v[104:107], v2 offset:2752
    ds_read_b64 v[72:73], v3 offset:1216
    ds_read_b64 v[74:75], v3 offset:1224
    ds_read_b128 v[108:111], v2 offset:2240
    ds_read_b64 v[76:77], v3 offset:1728
    ds_read_b64 v[78:79], v3 offset:1736
    ds_read_b128 v[112:115], v2 offset:1728
    ds_read_b64 v[80:81], v3 offset:2240
    ds_read_b64 v[82:83], v3 offset:2248
    ds_read_b128 v[116:119], v2 offset:1216
    ds_read_b64 v[84:85], v3 offset:2752
    ds_read_b64 v[86:87], v3 offset:2760
    ds_read_b128 v[120:123], v2 offset:704
    ds_read_b64 v[88:89], v3 offset:3264
    ds_read_b64 v[90:91], v3 offset:3272
    ds_read_b128 v[124:127], v2 offset:192
    ds_read_b64 v[92:93], v3 offset:3776
    ds_read_b64 v[94:95], v3 offset:3784
    s_waitcnt lgkmcnt(15)
    v_mfma_f32_16x16x32_bf16 v[16:19], v[64:67], v[96:99], 0
    s_waitcnt lgkmcnt(15)
    v_mfma_f32_16x16x32_bf16 v[20:23], v[68:71], v[96:99], 0
    v_mfma_f32_16x16x32_bf16 v[20:23], v[64:67], v[100:103], v[20:23]
    v_mfma_f32_16x16x32_bf16 v[24:27], v[68:71], v[100:103], 0
    ds_read_b128 v[160:163], v2 offset:3712
    ds_read_b64 v[128:129], v3 offset:128
    ds_read_b64 v[130:131], v3 offset:136
    s_waitcnt lgkmcnt(15)
    v_mfma_f32_16x16x32_bf16 v[24:27], v[72:75], v[96:99], v[24:27]
    v_mfma_f32_16x16x32_bf16 v[28:31], v[72:75], v[100:103], 0
    v_mfma_f32_16x16x32_bf16 v[24:27], v[64:67], v[104:107], v[24:27]
    v_mfma_f32_16x16x32_bf16 v[28:31], v[68:71], v[104:107], v[28:31]
    ds_read_b128 v[164:167], v2 offset:3200
    ds_read_b64 v[132:133], v3 offset:640
    ds_read_b64 v[134:135], v3 offset:648
    v_mfma_f32_16x16x32_bf16 v[32:35], v[72:75], v[104:107], 0
    s_waitcnt lgkmcnt(15)
    v_mfma_f32_16x16x32_bf16 v[28:31], v[76:79], v[96:99], v[28:31]
    v_mfma_f32_16x16x32_bf16 v[32:35], v[76:79], v[100:103], v[32:35]
    v_mfma_f32_16x16x32_bf16 v[36:39], v[76:79], v[104:107], 0
    ds_read_b128 v[168:171], v2 offset:2688
    ds_read_b64 v[136:137], v3 offset:1152
    ds_read_b64 v[138:139], v3 offset:1160
    v_mfma_f32_16x16x32_bf16 v[28:31], v[64:67], v[108:111], v[28:31]
    v_mfma_f32_16x16x32_bf16 v[32:35], v[68:71], v[108:111], v[32:35]
    v_mfma_f32_16x16x32_bf16 v[36:39], v[72:75], v[108:111], v[36:39]
    v_mfma_f32_16x16x32_bf16 v[40:43], v[76:79], v[108:111], 0
    ds_read_b128 v[172:175], v2 offset:2176
    ds_read_b64 v[140:141], v3 offset:1664
    ds_read_b64 v[142:143], v3 offset:1672
    s_waitcnt lgkmcnt(15)
    v_mfma_f32_16x16x32_bf16 v[32:35], v[80:83], v[96:99], v[32:35]
    v_mfma_f32_16x16x32_bf16 v[36:39], v[80:83], v[100:103], v[36:39]
    v_mfma_f32_16x16x32_bf16 v[40:43], v[80:83], v[104:107], v[40:43]
    v_mfma_f32_16x16x32_bf16 v[44:47], v[80:83], v[108:111], 0
    ds_read_b128 v[176:179], v2 offset:1664
    ds_read_b64 v[144:145], v3 offset:2176
    ds_read_b64 v[146:147], v3 offset:2184
    v_mfma_f32_16x16x32_bf16 v[32:35], v[64:67], v[112:115], v[32:35]
    v_mfma_f32_16x16x32_bf16 v[36:39], v[68:71], v[112:115], v[36:39]
    v_mfma_f32_16x16x32_bf16 v[40:43], v[72:75], v[112:115], v[40:43]
    v_mfma_f32_16x16x32_bf16 v[44:47], v[76:79], v[112:115], v[44:47]
    ds_read_b128 v[180:183], v2 offset:1152
    ds_read_b64 v[148:149], v3 offset:2688
    ds_read_b64 v[150:151], v3 offset:2696
    s_waitcnt lgkmcnt(15)
    v_mfma_f32_16x16x32_bf16 v[36:39], v[84:87], v[96:99], v[36:39]
    v_mfma_f32_16x16x32_bf16 v[40:43], v[84:87], v[100:103], v[40:43]
    v_mfma_f32_16x16x32_bf16 v[44:47], v[84:87], v[104:107], v[44:47]
    v_mfma_f32_16x16x32_bf16 v[36:39], v[64:67], v[116:119], v[36:39]
    ds_read_b128 v[184:187], v2 offset:640
    ds_read_b64 v[152:153], v3 offset:3200
    ds_read_b64 v[154:155], v3 offset:3208
    v_mfma_f32_16x16x32_bf16 v[40:43], v[68:71], v[116:119], v[40:43]
    v_mfma_f32_16x16x32_bf16 v[44:47], v[72:75], v[116:119], v[44:47]
    s_waitcnt lgkmcnt(15)
    v_mfma_f32_16x16x32_bf16 v[40:43], v[88:91], v[96:99], v[40:43]
    v_mfma_f32_16x16x32_bf16 v[44:47], v[88:91], v[100:103], v[44:47]
    ds_read_b128 v[188:191], v2 offset:128
    ds_read_b64 v[156:157], v3 offset:3712
    ds_read_b64 v[158:159], v3 offset:3720
    v_mfma_f32_16x16x32_bf16 v[40:43], v[64:67], v[120:123], v[40:43]
    v_mfma_f32_16x16x32_bf16 v[44:47], v[68:71], v[120:123], v[44:47]
    s_waitcnt lgkmcnt(15)
    v_mfma_f32_16x16x32_bf16 v[44:47], v[92:95], v[96:99], v[44:47]
    v_mfma_f32_16x16x32_bf16 v[44:47], v[64:67], v[124:127], v[44:47]
    s_waitcnt lgkmcnt(15)
    v_mfma_f32_16x16x32_bf16 v[16:19], v[128:131], v[160:163], v[16:19]
    s_waitcnt lgkmcnt(15)
    v_mfma_f32_16x16x32_bf16 v[20:23], v[132:135], v[160:163], v[20:23]
    v_mfma_f32_16x16x32_bf16 v[20:23], v[128:131], v[164:167], v[20:23]
    v_mfma_f32_16x16x32_bf16 v[24:27], v[132:135], v[164:167], v[24:27]
    ds_read_b128 v[96:99], v2 offset:3648
    ds_read_b64 v[64:65], v3 offset:64
    ds_read_b64 v[66:67], v3 offset:72
    s_waitcnt lgkmcnt(15)
    v_mfma_f32_16x16x32_bf16 v[24:27], v[136:139], v[160:163], v[24:27]
    v_mfma_f32_16x16x32_bf16 v[28:31], v[136:139], v[164:167], v[28:31]
    v_mfma_f32_16x16x32_bf16 v[24:27], v[128:131], v[168:171], v[24:27]
    v_mfma_f32_16x16x32_bf16 v[28:31], v[132:135], v[168:171], v[28:31]
    ds_read_b128 v[100:103], v2 offset:3136
    ds_read_b64 v[68:69], v3 offset:576
    ds_read_b64 v[70:71], v3 offset:584
    v_mfma_f32_16x16x32_bf16 v[32:35], v[136:139], v[168:171], v[32:35]
    s_waitcnt lgkmcnt(15)
    v_mfma_f32_16x16x32_bf16 v[28:31], v[140:143], v[160:163], v[28:31]
    v_mfma_f32_16x16x32_bf16 v[32:35], v[140:143], v[164:167], v[32:35]
    v_mfma_f32_16x16x32_bf16 v[36:39], v[140:143], v[168:171], v[36:39]
    ds_read_b128 v[104:107], v2 offset:2624
    ds_read_b64 v[72:73], v3 offset:1088
    ds_read_b64 v[74:75], v3 offset:1096
    v_mfma_f32_16x16x32_bf16 v[28:31], v[128:131], v[172:175], v[28:31]
    v_mfma_f32_16x16x32_bf16 v[32:35], v[132:135], v[172:175], v[32:35]
    v_mfma_f32_16x16x32_bf16 v[36:39], v[136:139], v[172:175], v[36:39]
    v_mfma_f32_16x16x32_bf16 v[40:43], v[140:143], v[172:175], v[40:43]
    ds_read_b128 v[108:111], v2 offset:2112
    ds_read_b64 v[76:77], v3 offset:1600
    ds_read_b64 v[78:79], v3 offset:1608
    s_waitcnt lgkmcnt(15)
    v_mfma_f32_16x16x32_bf16 v[32:35], v[144:147], v[160:163], v[32:35]
    v_mfma_f32_16x16x32_bf16 v[36:39], v[144:147], v[164:167], v[36:39]
    v_mfma_f32_16x16x32_bf16 v[40:43], v[144:147], v[168:171], v[40:43]
    v_mfma_f32_16x16x32_bf16 v[44:47], v[144:147], v[172:175], v[44:47]
    ds_read_b128 v[112:115], v2 offset:1600
    ds_read_b64 v[80:81], v3 offset:2112
    ds_read_b64 v[82:83], v3 offset:2120
    v_mfma_f32_16x16x32_bf16 v[32:35], v[128:131], v[176:179], v[32:35]
    v_mfma_f32_16x16x32_bf16 v[36:39], v[132:135], v[176:179], v[36:39]
    v_mfma_f32_16x16x32_bf16 v[40:43], v[136:139], v[176:179], v[40:43]
    v_mfma_f32_16x16x32_bf16 v[44:47], v[140:143], v[176:179], v[44:47]
    ds_read_b128 v[116:119], v2 offset:1088
    ds_read_b64 v[84:85], v3 offset:2624
    ds_read_b64 v[86:87], v3 offset:2632
    s_waitcnt lgkmcnt(15)
    v_mfma_f32_16x16x32_bf16 v[36:39], v[148:151], v[160:163], v[36:39]
    v_mfma_f32_16x16x32_bf16 v[40:43], v[148:151], v[164:167], v[40:43]
    v_mfma_f32_16x16x32_bf16 v[44:47], v[148:151], v[168:171], v[44:47]
    v_mfma_f32_16x16x32_bf16 v[36:39], v[128:131], v[180:183], v[36:39]
    ds_read_b128 v[120:123], v2 offset:576
    ds_read_b64 v[88:89], v3 offset:3136
    ds_read_b64 v[90:91], v3 offset:3144
    v_mfma_f32_16x16x32_bf16 v[40:43], v[132:135], v[180:183], v[40:43]
    v_mfma_f32_16x16x32_bf16 v[44:47], v[136:139], v[180:183], v[44:47]
    s_waitcnt lgkmcnt(15)
    v_mfma_f32_16x16x32_bf16 v[40:43], v[152:155], v[160:163], v[40:43]
    v_mfma_f32_16x16x32_bf16 v[44:47], v[152:155], v[164:167], v[44:47]
    ds_read_b128 v[124:127], v2 offset:64
    ds_read_b64 v[92:93], v3 offset:3648
    ds_read_b64 v[94:95], v3 offset:3656
    v_mfma_f32_16x16x32_bf16 v[40:43], v[128:131], v[184:187], v[40:43]
    v_mfma_f32_16x16x32_bf16 v[44:47], v[132:135], v[184:187], v[44:47]
    s_waitcnt lgkmcnt(15)
    v_mfma_f32_16x16x32_bf16 v[44:47], v[156:159], v[160:163], v[44:47]
    v_mfma_f32_16x16x32_bf16 v[44:47], v[128:131], v[188:191], v[44:47]
    s_waitcnt lgkmcnt(15)
    v_mfma_f32_16x16x32_bf16 v[16:19], v[64:67], v[96:99], v[16:19]
    s_waitcnt lgkmcnt(15)
    v_mfma_f32_16x16x32_bf16 v[20:23], v[68:71], v[96:99], v[20:23]
    v_mfma_f32_16x16x32_bf16 v[20:23], v[64:67], v[100:103], v[20:23]
    v_mfma_f32_16x16x32_bf16 v[24:27], v[68:71], v[100:103], v[24:27]
    ds_read_b128 v[160:163], v2 offset:3584
    ds_read_b64 v[128:129], v3 offset:0
    ds_read_b64 v[130:131], v3 offset:8
    s_waitcnt lgkmcnt(15)
    v_mfma_f32_16x16x32_bf16 v[24:27], v[72:75], v[96:99], v[24:27]
    v_mfma_f32_16x16x32_bf16 v[28:31], v[72:75], v[100:103], v[28:31]
    v_mfma_f32_16x16x32_bf16 v[24:27], v[64:67], v[104:107], v[24:27]
    v_mfma_f32_16x16x32_bf16 v[28:31], v[68:71], v[104:107], v[28:31]
    ds_read_b128 v[164:167], v2 offset:3072
    ds_read_b64 v[132:133], v3 offset:512
    ds_read_b64 v[134:135], v3 offset:520
    v_mfma_f32_16x16x32_bf16 v[32:35], v[72:75], v[104:107], v[32:35]
    s_waitcnt lgkmcnt(15)
    v_mfma_f32_16x16x32_bf16 v[28:31], v[76:79], v[96:99], v[28:31]
    v_mfma_f32_16x16x32_bf16 v[32:35], v[76:79], v[100:103], v[32:35]
    v_mfma_f32_16x16x32_bf16 v[36:39], v[76:79], v[104:107], v[36:39]
    ds_read_b128 v[168:171], v2 offset:2560
    ds_read_b64 v[136:137], v3 offset:1024
    ds_read_b64 v[138:139], v3 offset:1032
    v_mfma_f32_16x16x32_bf16 v[28:31], v[64:67], v[108:111], v[28:31]
    v_mfma_f32_16x16x32_bf16 v[32:35], v[68:71], v[108:111], v[32:35]
    v_mfma_f32_16x16x32_bf16 v[36:39], v[72:75], v[108:111], v[36:39]
    v_mfma_f32_16x16x32_bf16 v[40:43], v[76:79], v[108:111], v[40:43]
    ds_read_b128 v[172:175], v2 offset:2048
    ds_read_b64 v[140:141], v3 offset:1536
    ds_read_b64 v[142:143], v3 offset:1544
    s_waitcnt lgkmcnt(15)
    v_mfma_f32_16x16x32_bf16 v[32:35], v[80:83], v[96:99], v[32:35]
    v_mfma_f32_16x16x32_bf16 v[36:39], v[80:83], v[100:103], v[36:39]
    v_mfma_f32_16x16x32_bf16 v[40:43], v[80:83], v[104:107], v[40:43]
    v_mfma_f32_16x16x32_bf16 v[44:47], v[80:83], v[108:111], v[44:47]
    ds_read_b128 v[176:179], v2 offset:1536
    ds_read_b64 v[144:145], v3 offset:2048
    ds_read_b64 v[146:147], v3 offset:2056
    v_mfma_f32_16x16x32_bf16 v[32:35], v[64:67], v[112:115], v[32:35]
    v_mfma_f32_16x16x32_bf16 v[36:39], v[68:71], v[112:115], v[36:39]
    v_mfma_f32_16x16x32_bf16 v[40:43], v[72:75], v[112:115], v[40:43]
    v_mfma_f32_16x16x32_bf16 v[44:47], v[76:79], v[112:115], v[44:47]
    ds_read_b128 v[180:183], v2 offset:1024
    ds_read_b64 v[148:149], v3 offset:2560
    ds_read_b64 v[150:151], v3 offset:2568
    s_waitcnt lgkmcnt(15)
    v_mfma_f32_16x16x32_bf16 v[36:39], v[84:87], v[96:99], v[36:39]
    v_mfma_f32_16x16x32_bf16 v[40:43], v[84:87], v[100:103], v[40:43]
    v_mfma_f32_16x16x32_bf16 v[44:47], v[84:87], v[104:107], v[44:47]
    v_mfma_f32_16x16x32_bf16 v[36:39], v[64:67], v[116:119], v[36:39]
    ds_read_b128 v[184:187], v2 offset:512
    ds_read_b64 v[152:153], v3 offset:3072
    ds_read_b64 v[154:155], v3 offset:3080
    v_mfma_f32_16x16x32_bf16 v[40:43], v[68:71], v[116:119], v[40:43]
    v_mfma_f32_16x16x32_bf16 v[44:47], v[72:75], v[116:119], v[44:47]
    s_waitcnt lgkmcnt(15)
    v_mfma_f32_16x16x32_bf16 v[40:43], v[88:91], v[96:99], v[40:43]
    v_mfma_f32_16x16x32_bf16 v[44:47], v[88:91], v[100:103], v[44:47]
    ds_read_b128 v[188:191], v2 offset:0
    ds_read_b64 v[156:157], v3 offset:3584
    ds_read_b64 v[158:159], v3 offset:3592
    v_mfma_f32_16x16x32_bf16 v[40:43], v[64:67], v[120:123], v[40:43]
    v_mfma_f32_16x16x32_bf16 v[44:47], v[68:71], v[120:123], v[44:47]
    s_waitcnt lgkmcnt(15)
    v_mfma_f32_16x16x32_bf16 v[44:47], v[92:95], v[96:99], v[44:47]
    v_mfma_f32_16x16x32_bf16 v[44:47], v[64:67], v[124:127], v[44:47]
    s_waitcnt lgkmcnt(15)
    v_mfma_f32_16x16x32_bf16 v[16:19], v[128:131], v[160:163], v[16:19]
    s_waitcnt lgkmcnt(15)
    v_mfma_f32_16x16x32_bf16 v[20:23], v[132:135], v[160:163], v[20:23]
    v_mfma_f32_16x16x32_bf16 v[20:23], v[128:131], v[164:167], v[20:23]
    v_mfma_f32_16x16x32_bf16 v[24:27], v[132:135], v[164:167], v[24:27]
    s_waitcnt lgkmcnt(15)
    v_mfma_f32_16x16x32_bf16 v[24:27], v[136:139], v[160:163], v[24:27]
    v_mfma_f32_16x16x32_bf16 v[28:31], v[136:139], v[164:167], v[28:31]
    v_mfma_f32_16x16x32_bf16 v[24:27], v[128:131], v[168:171], v[24:27]
    v_mfma_f32_16x16x32_bf16 v[28:31], v[132:135], v[168:171], v[28:31]
    v_mfma_f32_16x16x32_bf16 v[32:35], v[136:139], v[168:171], v[32:35]
    s_waitcnt lgkmcnt(12)
    v_mfma_f32_16x16x32_bf16 v[28:31], v[140:143], v[160:163], v[28:31]
    v_mfma_f32_16x16x32_bf16 v[32:35], v[140:143], v[164:167], v[32:35]
    v_mfma_f32_16x16x32_bf16 v[36:39], v[140:143], v[168:171], v[36:39]
    v_mfma_f32_16x16x32_bf16 v[28:31], v[128:131], v[172:175], v[28:31]
    v_mfma_f32_16x16x32_bf16 v[32:35], v[132:135], v[172:175], v[32:35]
    v_mfma_f32_16x16x32_bf16 v[36:39], v[136:139], v[172:175], v[36:39]
    v_mfma_f32_16x16x32_bf16 v[40:43], v[140:143], v[172:175], v[40:43]
    s_waitcnt lgkmcnt(9)
    v_mfma_f32_16x16x32_bf16 v[32:35], v[144:147], v[160:163], v[32:35]
    v_mfma_f32_16x16x32_bf16 v[36:39], v[144:147], v[164:167], v[36:39]
    v_mfma_f32_16x16x32_bf16 v[40:43], v[144:147], v[168:171], v[40:43]
    v_mfma_f32_16x16x32_bf16 v[44:47], v[144:147], v[172:175], v[44:47]
    v_mfma_f32_16x16x32_bf16 v[32:35], v[128:131], v[176:179], v[32:35]
    v_mfma_f32_16x16x32_bf16 v[36:39], v[132:135], v[176:179], v[36:39]
    v_mfma_f32_16x16x32_bf16 v[40:43], v[136:139], v[176:179], v[40:43]
    v_mfma_f32_16x16x32_bf16 v[44:47], v[140:143], v[176:179], v[44:47]
    s_waitcnt lgkmcnt(6)
    v_mfma_f32_16x16x32_bf16 v[36:39], v[148:151], v[160:163], v[36:39]
    v_mfma_f32_16x16x32_bf16 v[40:43], v[148:151], v[164:167], v[40:43]
    v_mfma_f32_16x16x32_bf16 v[44:47], v[148:151], v[168:171], v[44:47]
    v_mfma_f32_16x16x32_bf16 v[36:39], v[128:131], v[180:183], v[36:39]
    v_mfma_f32_16x16x32_bf16 v[40:43], v[132:135], v[180:183], v[40:43]
    v_mfma_f32_16x16x32_bf16 v[44:47], v[136:139], v[180:183], v[44:47]
    s_waitcnt lgkmcnt(3)
    v_mfma_f32_16x16x32_bf16 v[40:43], v[152:155], v[160:163], v[40:43]
    v_mfma_f32_16x16x32_bf16 v[44:47], v[152:155], v[164:167], v[44:47]
    v_mfma_f32_16x16x32_bf16 v[40:43], v[128:131], v[184:187], v[40:43]
    v_mfma_f32_16x16x32_bf16 v[44:47], v[132:135], v[184:187], v[44:47]
    s_waitcnt lgkmcnt(0)
    v_mfma_f32_16x16x32_bf16 v[44:47], v[156:159], v[160:163], v[44:47]
    v_mfma_f32_16x16x32_bf16 v[44:47], v[128:131], v[188:191], v[44:47]
    s_lshl_b32 s42, s40, 12
    s_add_u32 s42, s42, 33280
    v_lshlrev_b32 v6, 4, v1
    v_add_u32 v7, s42, v6
    s_xor_b32 s43, s40, 1
    s_lshl_b32 s43, s43, 12
    s_add_u32 s43, s43, 33280
    v_add_u32 v8, s43, v6
    s_cmp_eq_u32 s80, 0
    s_cbranch_scc1 L_cv_x0
    s_nop 7
    ds_write_b128 v7, v[16:19] offset:0
    ds_write_b128 v7, v[20:23] offset:1024
    ds_write_b128 v7, v[24:27] offset:2048
    ds_write_b128 v7, v[28:31] offset:3072
    s_nop 1
    v_mov_b32 v16, v32
    v_mov_b32 v17, v33
    v_mov_b32 v18, v34
    v_mov_b32 v19, v35
    v_mov_b32 v20, v36
    v_mov_b32 v21, v37
    v_mov_b32 v22, v38
    v_mov_b32 v23, v39
    v_mov_b32 v24, v40
    v_mov_b32 v25, v41
    v_mov_b32 v26, v42
    v_mov_b32 v27, v43
    v_mov_b32 v28, v44
    v_mov_b32 v29, v45
    v_mov_b32 v30, v46
    v_mov_b32 v31, v47
    s_branch L_cv_x1
L_cv_x0:
    s_nop 7
    ds_write_b128 v7, v[32:35] offset:0
    ds_write_b128 v7, v[36:39] offset:1024
    ds_write_b128 v7, v[40:43] offset:2048
    ds_write_b128 v7, v[44:47] offset:3072
L_cv_x1:
    s_waitcnt lgkmcnt(0)
    s_barrier
    ds_read_b128 v[64:67], v8 offset:0
    ds_read_b128 v[68:71], v8 offset:1024
    ds_read_b128 v[72:75], v8 offset:2048
    ds_read_b128 v[76:79], v8 offset:3072
    v_lshlrev_b32 v9, 5, v4
    v_lshl_add_u32 v9, v5, 3, v9
    s_lshl_b32 s43, s80, 11
    v_add_u32 v9, s43, v9
    s_mul_i32 s42, s79, 16640
    s_add_u32 s42, s42, 32
    v_add_u32 v10, s42, v9
    ds_read_b64 v[96:97], v10 offset:0
    ds_read_b64 v[98:99], v10 offset:512
    ds_read_b64 v[100:101], v10 offset:1024
    ds_read_b64 v[102:103], v10 offset:1536
    s_lshl_b32 s42, s81, 12
    s_add_u32 s42, s42, 0x200000
    v_add_u32 v9, s42, v9
    s_mov_b32 s48, s38
    s_mov_b32 s49, s39
    s_mov_b32 s50, 0x1000000
    s_mov_b32 s51, 0x20000
    s_waitcnt lgkmcnt(7)
    v_add_f32 v16, v16, v64
    v_add_f32 v17, v17, v65
    v_add_f32 v18, v18, v66
    v_add_f32 v19, v19, v67
    s_waitcnt lgkmcnt(6)
    v_add_f32 v20, v20, v68
    v_add_f32 v21, v21, v69
    v_add_f32 v22, v22, v70
    v_add_f32 v23, v23, v71
    s_waitcnt lgkmcnt(5)
    v_add_f32 v24, v24, v72
    v_add_f32 v25, v25, v73
    v_add_f32 v26, v26, v74
    v_add_f32 v27, v27, v75
    s_waitcnt lgkmcnt(4)
    v_add_f32 v28, v28, v76
    v_add_f32 v29, v29, v77
    v_add_f32 v30, v30, v78
    v_add_f32 v31, v31, v79
    s_waitcnt lgkmcnt(3)
    v_lshlrev_b32 v104, 16, v96
    v_and_b32 v105, 0xffff0000, v96
    v_lshlrev_b32 v106, 16, v97
    v_and_b32 v107, 0xffff0000, v97
    v_mul_f32 v104, s78, v104
    v_mul_f32 v105, s78, v105
    v_mul_f32 v106, s78, v106
    v_mul_f32 v107, s78, v107
    v_cvt_pk_bf16_f32 v104, v104, v105
    v_cvt_pk_bf16_f32 v105, v106, v107
    v_cvt_pk_bf16_f32 v16, v16, v17
    v_cvt_pk_bf16_f32 v17, v18, v19
    v_lshlrev_b32 v108, 16, v104
    v_and_b32 v109, 0xffff0000, v104
    v_lshlrev_b32 v112, 16, v16
    v_and_b32 v113, 0xffff0000, v16
    v_lshlrev_b32 v110, 16, v105
    v_and_b32 v111, 0xffff0000, v105
    v_lshlrev_b32 v114, 16, v17
    v_and_b32 v115, 0xffff0000, v17
    v_add_f32 v108, v108, v112
    v_add_f32 v109, v109, v113
    v_add_f32 v110, v110, v114
    v_add_f32 v111, v111, v115
    v_cvt_pk_bf16_f32 v112, v108, v109
    v_cvt_pk_bf16_f32 v113, v110, v111
    buffer_store_dwordx2 v[112:113], v9, s[48:51], 0 offen offset:0 sc1
    s_waitcnt lgkmcnt(2)
    v_lshlrev_b32 v104, 16, v98
    v_and_b32 v105, 0xffff0000, v98
    v_lshlrev_b32 v106, 16, v99
    v_and_b32 v107, 0xffff0000, v99
    v_mul_f32 v104, s78, v104
    v_mul_f32 v105, s78, v105
    v_mul_f32 v106, s78, v106
    v_mul_f32 v107, s78, v107
    v_cvt_pk_bf16_f32 v104, v104, v105
    v_cvt_pk_bf16_f32 v105, v106, v107
    v_cvt_pk_bf16_f32 v20, v20, v21
    v_cvt_pk_bf16_f32 v21, v22, v23
    v_lshlrev_b32 v108, 16, v104
    v_and_b32 v109, 0xffff0000, v104
    v_lshlrev_b32 v112, 16, v20
    v_and_b32 v113, 0xffff0000, v20
    v_lshlrev_b32 v110, 16, v105
    v_and_b32 v111, 0xffff0000, v105
    v_lshlrev_b32 v114, 16, v21
    v_and_b32 v115, 0xffff0000, v21
    v_add_f32 v108, v108, v112
    v_add_f32 v109, v109, v113
    v_add_f32 v110, v110, v114
    v_add_f32 v111, v111, v115
    v_cvt_pk_bf16_f32 v114, v108, v109
    v_cvt_pk_bf16_f32 v115, v110, v111
    buffer_store_dwordx2 v[114:115], v9, s[48:51], 0 offen offset:512 sc1
    s_waitcnt lgkmcnt(1)
    v_lshlrev_b32 v104, 16, v100
    v_and_b32 v105, 0xffff0000, v100
    v_lshlrev_b32 v106, 16, v101
    v_and_b32 v107, 0xffff0000, v101
    v_mul_f32 v104, s78, v104
    v_mul_f32 v105, s78, v105
    v_mul_f32 v106, s78, v106
    v_mul_f32 v107, s78, v107
    v_cvt_pk_bf16_f32 v104, v104, v105
    v_cvt_pk_bf16_f32 v105, v106, v107
    v_cvt_pk_bf16_f32 v24, v24, v25
    v_cvt_pk_bf16_f32 v25, v26, v27
    v_lshlrev_b32 v108, 16, v104
    v_and_b32 v109, 0xffff0000, v104
    v_lshlrev_b32 v112, 16, v24
    v_and_b32 v113, 0xffff0000, v24
    v_lshlrev_b32 v110, 16, v105
    v_and_b32 v111, 0xffff0000, v105
    v_lshlrev_b32 v114, 16, v25
    v_and_b32 v115, 0xffff0000, v25
    v_add_f32 v108, v108, v112
    v_add_f32 v109, v109, v113
    v_add_f32 v110, v110, v114
    v_add_f32 v111, v111, v115
    v_cvt_pk_bf16_f32 v116, v108, v109
    v_cvt_pk_bf16_f32 v117, v110, v111
    buffer_store_dwordx2 v[116:117], v9, s[48:51], 0 offen offset:1024 sc1
    s_waitcnt lgkmcnt(0)
    v_lshlrev_b32 v104, 16, v102
    v_and_b32 v105, 0xffff0000, v102
    v_lshlrev_b32 v106, 16, v103
    v_and_b32 v107, 0xffff0000, v103
    v_mul_f32 v104, s78, v104
    v_mul_f32 v105, s78, v105
    v_mul_f32 v106, s78, v106
    v_mul_f32 v107, s78, v107
    v_cvt_pk_bf16_f32 v104, v104, v105
    v_cvt_pk_bf16_f32 v105, v106, v107
    v_cvt_pk_bf16_f32 v28, v28, v29
    v_cvt_pk_bf16_f32 v29, v30, v31
    v_lshlrev_b32 v108, 16, v104
    v_and_b32 v109, 0xffff0000, v104
    v_lshlrev_b32 v112, 16, v28
    v_and_b32 v113, 0xffff0000, v28
    v_lshlrev_b32 v110, 16, v105
    v_and_b32 v111, 0xffff0000, v105
    v_lshlrev_b32 v114, 16, v29
    v_and_b32 v115, 0xffff0000, v29
    v_add_f32 v108, v108, v112
    v_add_f32 v109, v109, v113
    v_add_f32 v110, v110, v114
    v_add_f32 v111, v111, v115
    v_cvt_pk_bf16_f32 v118, v108, v109
    v_cvt_pk_bf16_f32 v119, v110, v111
    buffer_store_dwordx2 v[118:119], v9, s[48:51], 0 offen offset:1536 sc1
    s_waitcnt vmcnt(0)
    s_barrier
    s_cmp_eq_u32 s40, 0
    s_cbranch_scc0 L_ssm_pub2_skip
    s_lshl_b32 s42, s41, 5
    s_add_u32 s42, s42, 8192
    v_mov_b32 v35, s42
    v_mov_b32 v36, 1
    s_mov_b64 exec, 1
    buffer_store_dword v36, v35, s[64:67], 0 offen offset:0 sc1
    s_mov_b64 exec, -1
L_ssm_pub2_skip:
    s_endpgm
.p2align 8
KIDX_TABLE:
.long 14, 12, 10, 8, 6, 4, 2, 0
.long 30, 28, 26, 24, 22, 20, 18, 16
.long 46, 44, 42, 40, 38, 36, 34, 32
.long 62, 60, 58, 56, 54, 52, 50, 48
.long 78, 76, 74, 72, 70, 68, 66, 64
.long 94, 92, 90, 88, 86, 84, 82, 80
.long 110, 108, 106, 104, 102, 100, 98, 96
.long 126, 124, 122, 120, 118, 116, 114, 112
.long 142, 140, 138, 136, 134, 132, 130, 128
.long 158, 156, 154, 152, 150, 148, 146, 144
.long 174, 172, 170, 168, 166, 164, 162, 160
.long 190, 188, 186, 184, 182, 180, 178, 176
.long 206, 204, 202, 200, 198, 196, 194, 192
.long 222, 220, 218, 216, 214, 212, 210, 208
.long 238, 236, 234, 232, 230, 228, 226, 224
.long 254, 252, 250, 248, 246, 244, 242, 240
.long 270, 268, 266, 264, 262, 260, 258, 256
.long 286, 284, 282, 280, 278, 276, 274, 272
.long 302, 300, 298, 296, 294, 292, 290, 288
.long 318, 316, 314, 312, 310, 308, 306, 304
.long 334, 332, 330, 328, 326, 324, 322, 320
.long 350, 348, 346, 344, 342, 340, 338, 336
.long 366, 364, 362, 360, 358, 356, 354, 352
.long 382, 380, 378, 376, 374, 372, 370, 368
.long 398, 396, 394, 392, 390, 388, 386, 384
.long 414, 412, 410, 408, 406, 404, 402, 400
.long 430, 428, 426, 424, 422, 420, 418, 416
.long 446, 444, 442, 440, 438, 436, 434, 432
.long 462, 460, 458, 456, 454, 452, 450, 448
.long 478, 476, 474, 472, 470, 468, 466, 464
.long 494, 492, 490, 488, 486, 484, 482, 480
.long 510, 508, 506, 504, 502, 500, 498, 496
.long 520, 518, 516, 516, 516, 514, 512, 512
.long 528, 526, 524, 524, 524, 522, 520, 520
.long 536, 534, 532, 532, 532, 530, 528, 528
.long 544, 542, 540, 540, 540, 538, 536, 536
.long 552, 550, 548, 548, 548, 546, 544, 544
.long 560, 558, 556, 556, 556, 554, 552, 552
.long 568, 566, 564, 564, 564, 562, 560, 560
.long 576, 574, 572, 572, 572, 570, 568, 568
.long 584, 582, 580, 580, 580, 578, 576, 576
.long 592, 590, 588, 588, 588, 586, 584, 584
.long 600, 598, 596, 596, 596, 594, 592, 592
.long 608, 606, 604, 604, 604, 602, 600, 600
.long 616, 614, 612, 612, 612, 610, 608, 608
.long 624, 622, 620, 620, 620, 618, 616, 616
.long 632, 630, 628, 628, 628, 626, 624, 624
.long 640, 638, 636, 636, 636, 634, 632, 632
.long 648, 646, 644, 644, 644, 642, 640, 640
.long 656, 654, 652, 652, 652, 650, 648, 648
.long 664, 662, 660, 660, 660, 658, 656, 656
.long 672, 670, 668, 668, 668, 666, 664, 664
.long 680, 678, 676, 676, 676, 674, 672, 672
.long 688, 686, 684, 684, 684, 682, 680, 680
.long 696, 694, 692, 692, 692, 690, 688, 688
.long 704, 702, 700, 700, 700, 698, 696, 696
.long 712, 710, 708, 708, 708, 706, 704, 704
.long 720, 718, 716, 716, 716, 714, 712, 712
.long 728, 726, 724, 724, 724, 722, 720, 720
.long 736, 734, 732, 732, 732, 730, 728, 728
.long 744, 742, 740, 740, 740, 738, 736, 736
.long 752, 750, 748, 748, 748, 746, 744, 744
.long 760, 758, 756, 756, 756, 754, 752, 752
.long 768, 766, 764, 764, 764, 762, 760, 760
.long 772, 772, 770, 770, 770, 768, 768, 768
.long 776, 776, 774, 774, 774, 772, 772, 772
.long 780, 780, 778, 778, 778, 776, 776, 776
.long 784, 784, 782, 782, 782, 780, 780, 780
.long 788, 788, 786, 786, 786, 784, 784, 784
.long 792, 792, 790, 790, 790, 788, 788, 788
.long 796, 796, 794, 794, 794, 792, 792, 792
.long 800, 800, 798, 798, 798, 796, 796, 796
.long 804, 804, 802, 802, 802, 800, 800, 800
.long 808, 808, 806, 806, 806, 804, 804, 804
.long 812, 812, 810, 810, 810, 808, 808, 808
.long 816, 816, 814, 814, 814, 812, 812, 812
.long 820, 820, 818, 818, 818, 816, 816, 816
.long 824, 824, 822, 822, 822, 820, 820, 820
.long 828, 828, 826, 826, 826, 824, 824, 824
.long 832, 832, 830, 830, 830, 828, 828, 828
.long 836, 836, 834, 834, 834, 832, 832, 832
.long 840, 840, 838, 838, 838, 836, 836, 836
.long 844, 844, 842, 842, 842, 840, 840, 840
.long 848, 848, 846, 846, 846, 844, 844, 844
.long 852, 852, 850, 850, 850, 848, 848, 848
.long 856, 856, 854, 854, 854, 852, 852, 852
.long 860, 860, 858, 858, 858, 856, 856, 856
.long 864, 864, 862, 862, 862, 860, 860, 860
.long 868, 868, 866, 866, 866, 864, 864, 864
.long 872, 872, 870, 870, 870, 868, 868, 868
.long 876, 876, 874, 874, 874, 872, 872, 872
.long 880, 880, 878, 878, 878, 876, 876, 876
.long 884, 884, 882, 882, 882, 880, 880, 880
.long 888, 888, 886, 886, 886, 884, 884, 884
.long 892, 892, 890, 890, 890, 888, 888, 888
.long 896, 896, 894, 894, 894, 892, 892, 892
.long 900, 900, 898, 898, 898, 896, 896, 896
.long 904, 904, 902, 902, 902, 900, 900, 900
.long 908, 908, 906, 906, 906, 904, 904, 904
.long 912, 912, 910, 910, 910, 908, 908, 908
.long 916, 916, 914, 914, 914, 912, 912, 912
.long 920, 920, 918, 918, 918, 916, 916, 916
.long 924, 924, 922, 922, 922, 920, 920, 920
.long 928, 928, 926, 926, 926, 924, 924, 924
.long 932, 932, 930, 930, 930, 928, 928, 928
.long 936, 936, 934, 934, 934, 932, 932, 932
.long 940, 940, 938, 938, 938, 936, 936, 936
.long 944, 944, 942, 942, 942, 940, 940, 940
.long 948, 948, 946, 946, 946, 944, 944, 944
.long 952, 952, 950, 950, 950, 948, 948, 948
.long 956, 956, 954, 954, 954, 952, 952, 952
.long 960, 960, 958, 958, 958, 956, 956, 956
.long 964, 964, 962, 962, 962, 960, 960, 960
.long 968, 968, 966, 966, 966, 964, 964, 964
.long 972, 972, 970, 970, 970, 968, 968, 968
.long 976, 976, 974, 974, 974, 972, 972, 972
.long 980, 980, 978, 978, 978, 976, 976, 976
.long 984, 984, 982, 982, 982, 980, 980, 980
.long 988, 988, 986, 986, 986, 984, 984, 984
.long 992, 992, 990, 990, 990, 988, 988, 988
.long 996, 996, 994, 994, 994, 992, 992, 992
.long 1000, 1000, 998, 998, 998, 996, 996, 996
.long 1004, 1004, 1002, 1002, 1002, 1000, 1000, 1000
.long 1008, 1008, 1006, 1006, 1006, 1004, 1004, 1004
.long 1012, 1012, 1010, 1010, 1010, 1008, 1008, 1008
.long 1016, 1016, 1014, 1014, 1014, 1012, 1012, 1012
.long 1020, 1020, 1018, 1018, 1018, 1016, 1016, 1016
.long 1024, 1024, 1022, 1022, 1022, 1020, 1020, 1020
.long 1026, 1026, 1026, 1024, 1024, 1024, 1024, 1024
.long 1028, 1028, 1028, 1028, 1026, 1026, 1026, 1026
.long 1030, 1030, 1030, 1028, 1028, 1028, 1028, 1028
.long 1032, 1032, 1032, 1032, 1030, 1030, 1030, 1030
.long 1034, 1034, 1034, 1032, 1032, 1032, 1032, 1032
.long 1036, 1036, 1036, 1036, 1034, 1034, 1034, 1034
.long 1038, 1038, 1038, 1036, 1036, 1036, 1036, 1036
.long 1040, 1040, 1040, 1040, 1038, 1038, 1038, 1038
.long 1042, 1042, 1042, 1040, 1040, 1040, 1040, 1040
.long 1044, 1044, 1044, 1044, 1042, 1042, 1042, 1042
.long 1046, 1046, 1046, 1044, 1044, 1044, 1044, 1044
.long 1048, 1048, 1048, 1048, 1046, 1046, 1046, 1046
.long 1050, 1050, 1050, 1048, 1048, 1048, 1048, 1048
.long 1052, 1052, 1052, 1052, 1050, 1050, 1050, 1050
.long 1054, 1054, 1054, 1052, 1052, 1052, 1052, 1052
.long 1056, 1056, 1056, 1056, 1054, 1054, 1054, 1054
.long 1058, 1058, 1058, 1056, 1056, 1056, 1056, 1056
.long 1060, 1060, 1060, 1060, 1058, 1058, 1058, 1058
.long 1062, 1062, 1062, 1060, 1060, 1060, 1060, 1060
.long 1064, 1064, 1064, 1064, 1062, 1062, 1062, 1062
.long 1066, 1066, 1066, 1064, 1064, 1064, 1064, 1064
.long 1068, 1068, 1068, 1068, 1066, 1066, 1066, 1066
.long 1070, 1070, 1070, 1068, 1068, 1068, 1068, 1068
.long 1072, 1072, 1072, 1072, 1070, 1070, 1070, 1070
.long 1074, 1074, 1074, 1072, 1072, 1072, 1072, 1072
.long 1076, 1076, 1076, 1076, 1074, 1074, 1074, 1074
.long 1078, 1078, 1078, 1076, 1076, 1076, 1076, 1076
.long 1080, 1080, 1080, 1080, 1078, 1078, 1078, 1078
.long 1082, 1082, 1082, 1080, 1080, 1080, 1080, 1080
.long 1084, 1084, 1084, 1084, 1082, 1082, 1082, 1082
.long 1086, 1086, 1086, 1084, 1084, 1084, 1084, 1084
.long 1088, 1088, 1088, 1088, 1086, 1086, 1086, 1086
.long 1090, 1090, 1090, 1088, 1088, 1088, 1088, 1088
.long 1092, 1092, 1092, 1092, 1090, 1090, 1090, 1090
.long 1094, 1094, 1094, 1092, 1092, 1092, 1092, 1092
.long 1096, 1096, 1096, 1096, 1094, 1094, 1094, 1094
.long 1098, 1098, 1098, 1096, 1096, 1096, 1096, 1096
.long 1100, 1100, 1100, 1100, 1098, 1098, 1098, 1098
.long 1102, 1102, 1102, 1100, 1100, 1100, 1100, 1100
.long 1104, 1104, 1104, 1104, 1102, 1102, 1102, 1102
.long 1106, 1106, 1106, 1104, 1104, 1104, 1104, 1104
.long 1108, 1108, 1108, 1108, 1106, 1106, 1106, 1106
.long 1110, 1110, 1110, 1108, 1108, 1108, 1108, 1108
.long 1112, 1112, 1112, 1112, 1110, 1110, 1110, 1110
.long 1114, 1114, 1114, 1112, 1112, 1112, 1112, 1112
.long 1116, 1116, 1116, 1116, 1114, 1114, 1114, 1114
.long 1118, 1118, 1118, 1116, 1116, 1116, 1116, 1116
.long 1120, 1120, 1120, 1120, 1118, 1118, 1118, 1118
.long 1122, 1122, 1122, 1120, 1120, 1120, 1120, 1120
.long 1124, 1124, 1124, 1124, 1122, 1122, 1122, 1122
.long 1126, 1126, 1126, 1124, 1124, 1124, 1124, 1124
.long 1128, 1128, 1128, 1128, 1126, 1126, 1126, 1126
.long 1130, 1130, 1130, 1128, 1128, 1128, 1128, 1128
.long 1132, 1132, 1132, 1132, 1130, 1130, 1130, 1130
.long 1134, 1134, 1134, 1132, 1132, 1132, 1132, 1132
.long 1136, 1136, 1136, 1136, 1134, 1134, 1134, 1134
.long 1138, 1138, 1138, 1136, 1136, 1136, 1136, 1136
.long 1140, 1140, 1140, 1140, 1138, 1138, 1138, 1138
.long 1142, 1142, 1142, 1140, 1140, 1140, 1140, 1140
.long 1144, 1144, 1144, 1144, 1142, 1142, 1142, 1142
.long 1146, 1146, 1146, 1144, 1144, 1144, 1144, 1144
.long 1148, 1148, 1148, 1148, 1146, 1146, 1146, 1146
.long 1150, 1150, 1150, 1148, 1148, 1148, 1148, 1148
.long 1152, 1152, 1152, 1152, 1150, 1150, 1150, 1150
.long 1154, 1154, 1154, 1152, 1152, 1152, 1152, 1152
.long 1156, 1156, 1156, 1156, 1154, 1154, 1154, 1154
.long 1158, 1158, 1158, 1156, 1156, 1156, 1156, 1156
.long 1160, 1160, 1160, 1160, 1158, 1158, 1158, 1158
.long 1162, 1162, 1162, 1160, 1160, 1160, 1160, 1160
.long 1164, 1164, 1164, 1164, 1162, 1162, 1162, 1162
.long 1166, 1166, 1166, 1164, 1164, 1164, 1164, 1164
.long 1168, 1168, 1168, 1168, 1166, 1166, 1166, 1166
.long 1170, 1170, 1170, 1168, 1168, 1168, 1168, 1168
.long 1172, 1172, 1172, 1172, 1170, 1170, 1170, 1170
.long 1174, 1174, 1174, 1172, 1172, 1172, 1172, 1172
.long 1176, 1176, 1176, 1176, 1174, 1174, 1174, 1174
.long 1178, 1178, 1178, 1176, 1176, 1176, 1176, 1176
.long 1180, 1180, 1180, 1180, 1178, 1178, 1178, 1178
.long 1182, 1182, 1182, 1180, 1180, 1180, 1180, 1180
.long 1184, 1184, 1184, 1184, 1182, 1182, 1182, 1182
.long 1186, 1186, 1186, 1184, 1184, 1184, 1184, 1184
.long 1188, 1188, 1188, 1188, 1186, 1186, 1186, 1186
.long 1190, 1190, 1190, 1188, 1188, 1188, 1188, 1188
.long 1192, 1192, 1192, 1192, 1190, 1190, 1190, 1190
.long 1194, 1194, 1194, 1192, 1192, 1192, 1192, 1192
.long 1196, 1196, 1196, 1196, 1194, 1194, 1194, 1194
.long 1198, 1198, 1198, 1196, 1196, 1196, 1196, 1196
.long 1200, 1200, 1200, 1200, 1198, 1198, 1198, 1198
.long 1202, 1202, 1202, 1200, 1200, 1200, 1200, 1200
.long 1204, 1204, 1204, 1204, 1202, 1202, 1202, 1202
.long 1206, 1206, 1206, 1204, 1204, 1204, 1204, 1204
.long 1208, 1208, 1208, 1208, 1206, 1206, 1206, 1206
.long 1210, 1210, 1210, 1208, 1208, 1208, 1208, 1208
.long 1212, 1212, 1212, 1212, 1210, 1210, 1210, 1210
.long 1214, 1214, 1214, 1212, 1212, 1212, 1212, 1212
.long 1216, 1216, 1216, 1216, 1214, 1214, 1214, 1214
.long 1218, 1218, 1218, 1216, 1216, 1216, 1216, 1216
.long 1220, 1220, 1220, 1220, 1218, 1218, 1218, 1218
.long 1222, 1222, 1222, 1220, 1220, 1220, 1220, 1220
.long 1224, 1224, 1224, 1224, 1222, 1222, 1222, 1222
.long 1226, 1226, 1226, 1224, 1224, 1224, 1224, 1224
.long 1228, 1228, 1228, 1228, 1226, 1226, 1226, 1226
.long 1230, 1230, 1230, 1228, 1228, 1228, 1228, 1228
.long 1232, 1232, 1232, 1232, 1230, 1230, 1230, 1230
.long 1234, 1234, 1234, 1232, 1232, 1232, 1232, 1232
.long 1236, 1236, 1236, 1236, 1234, 1234, 1234, 1234
.long 1238, 1238, 1238, 1236, 1236, 1236, 1236, 1236
.long 1240, 1240, 1240, 1240, 1238, 1238, 1238, 1238
.long 1242, 1242, 1242, 1240, 1240, 1240, 1240, 1240
.long 1244, 1244, 1244, 1244, 1242, 1242, 1242, 1242
.long 1246, 1246, 1246, 1244, 1244, 1244, 1244, 1244
.long 1248, 1248, 1248, 1248, 1246, 1246, 1246, 1246
.long 1250, 1250, 1250, 1248, 1248, 1248, 1248, 1248
.long 1252, 1252, 1252, 1252, 1250, 1250, 1250, 1250
.long 1254, 1254, 1254, 1252, 1252, 1252, 1252, 1252
.long 1256, 1256, 1256, 1256, 1254, 1254, 1254, 1254
.long 1258, 1258, 1258, 1256, 1256, 1256, 1256, 1256
.long 1260, 1260, 1260, 1260, 1258, 1258, 1258, 1258
.long 1262, 1262, 1262, 1260, 1260, 1260, 1260, 1260
.long 1264, 1264, 1264, 1264, 1262, 1262, 1262, 1262
.long 1266, 1266, 1266, 1264, 1264, 1264, 1264, 1264
.long 1268, 1268, 1268, 1268, 1266, 1266, 1266, 1266
.long 1270, 1270, 1270, 1268, 1268, 1268, 1268, 1268
.long 1272, 1272, 1272, 1272, 1270, 1270, 1270, 1270
.long 1274, 1274, 1274, 1272, 1272, 1272, 1272, 1272
.long 1276, 1276, 1276, 1276, 1274, 1274, 1274, 1274
.long 1278, 1278, 1278, 1276, 1276, 1276, 1276, 1276
.long 1280, 1280, 1280, 1280, 1278, 1278, 1278, 1278

CODE_END:
.section .rodata,"a"
.p2align 6
.amdhsa_kernel gated_mix__ssm_conv_s4__mixer_channel_mlp__prompt_kernel
  .amdhsa_next_free_vgpr 256
  .amdhsa_next_free_sgpr 102
  .amdhsa_accum_offset 256
  .amdhsa_group_segment_fixed_size 0
  .amdhsa_kernarg_size 144
  .amdhsa_user_sgpr_count 2
  .amdhsa_user_sgpr_kernarg_segment_ptr 1
  .amdhsa_system_sgpr_workgroup_id_x 1
.end_amdhsa_kernel
```
